```python
import torch

def _softmax(x, axis=-1):
    return torch.softmax(x, dim=axis)
def _gelu(x):
    return torch.nn.functional.gelu(x, approximate="tanh")
def _silu(x):
    return torch.nn.functional.silu(x)
def _sigmoid(x):
    return torch.sigmoid(x)
def _layernorm(x, axis=-1, eps=1e-5):
    m = x.mean(dim=axis, keepdim=True)
    v = x.var(dim=axis, keepdim=True, unbiased=False)
    return (x - m) / torch.sqrt(v + eps)
def _scatter_add(tgt, idx, src, axis=0):
    return tgt.clone().index_add_(axis, idx, src)
def _segment_sum(src, seg, n):
    out = torch.zeros((n,) + src.shape[1:], dtype=src.dtype)
    return out.index_add_(0, seg, src)
def _pad(x, pw):
    flat = tuple(v for pair in reversed(pw) for v in pair)
    return torch.nn.functional.pad(x, flat)

kernel_name = 'interleave_layers__spectral_gfnet__glu_gated_geglu__prompt'

def setup_inputs():

    _w = (lambda a: (lambda t: t.to(torch.bfloat16) if t.is_floating_point() else t)(torch.as_tensor(a)))
    def _A_setup():
        B, S, D = 1, 2048, 1024
        Df = D // 2 + 1
        return {
            "x": _w((lambda *s: torch.randn(*s, dtype=torch.bfloat16) * 0.05)(B, S, D)),
            "w_r": _w((lambda *s: torch.randn(*s, dtype=torch.bfloat16) * 0.4)(S, Df) * 0.02),
            "w_i": _w((lambda *s: torch.randn(*s, dtype=torch.bfloat16) * 0.4)(S, Df) * 0.02),
        }
    _A_in = _A_setup()

    def _B_setup():
        B, S, Dm, Df = 1, 2048, 1024, 3584
        return {
            "x": _w((lambda *s: torch.randn(*s, dtype=torch.bfloat16) * 0.05)(B, S, Dm)),
            "w_gate": _w((lambda *s: torch.randn(*s, dtype=torch.bfloat16) * 0.4)(Dm, Df) * (Dm ** -0.5)),
            "w_up": _w((lambda *s: torch.randn(*s, dtype=torch.bfloat16) * 0.4)(Dm, Df) * (Dm ** -0.5)),
            "w_down": _w((lambda *s: torch.randn(*s, dtype=torch.bfloat16) * 0.4)(Df, Dm) * (Df ** -0.5)),
        }
    _B_in = _B_setup()

    return {
        "A_x": _A_in["x"],
        "A_w_r": _A_in["w_r"],
        "A_w_i": _A_in["w_i"],
        "B_x": _B_in["x"],
        "B_w_gate": _B_in["w_gate"],
        "B_w_up": _B_in["w_up"],
        "B_w_down": _B_in["w_down"],
    }

def reference(A_x, A_w_r, A_w_i, B_x, B_w_gate, B_w_up, B_w_down):
    def _A_ref(x, w_r, w_i):
        B, S, D = x.shape
        X = (lambda x, axes=(-2,-1): torch.fft.rfft2(x.float(), dim=axes))(x, axes=(-2, -1))
        W = w_r + 1j * w_i
        X = X * W
        y = (lambda x, s, axes=(-2,-1): torch.fft.irfft2(x, s=s, dim=axes).to(torch.bfloat16))(X, (S, D), axes=(-2, -1))
        return y

    def _B_ref(x, w_gate, w_up, w_down):
        g = torch.einsum("bsd,df->bsf", x, w_gate)
        u = torch.einsum("bsd,df->bsf", x, w_up)
        h = _gelu(g) * u
        return torch.einsum("bsf,fd->bsd", h, w_down)

    x = A_x
    x = x + _A_ref(_layernorm(x, axis=-1), A_w_r, A_w_i)
    x = x + _B_ref(_layernorm(x, axis=-1), B_w_gate, B_w_up, B_w_down)
    x = x + _A_ref(_layernorm(x, axis=-1), A_w_r, A_w_i)
    x = x + _B_ref(_layernorm(x, axis=-1), B_w_gate, B_w_up, B_w_down)
    return x
```

```asm
; @launch kernel=p1a_kernel grid=(512,1,1) block=(512,1,1) lds=49664
; @launch kernel=l1_kernel grid=(256,1,1) block=(512,1,1) lds=148544
; @launch kernel=l2_kernel grid=(256,1,1) block=(512,1,1) lds=148544
.amdgcn_target "amdgcn-amd-amdhsa--gfx950"
.text
.p2align 8
.globl p1a_kernel
.type p1a_kernel,@function
p1a_kernel:
  s_load_dwordx2 s[36:37], s[0:1], 72
  s_load_dwordx2 s[32:33], s[0:1], 0
  s_mov_b32 s38, 0
  s_mov_b32 s94, 0
  s_branch p1_body
.p2align 8
.globl p1b_kernel
.type p1b_kernel,@function
p1b_kernel:
  s_load_dwordx2 s[36:37], s[0:1], 72
  s_load_dwordx2 s[32:33], s[0:1], 0
  s_mov_b32 s38, 1
  s_mov_b32 s94, 0
  s_branch p1_body
p1_fused:
  s_load_dwordx2 s[36:37], s[0:1], 72
  s_load_dwordx2 s[32:33], s[0:1], 0
  s_and_b32 s38, s94, 1
p1_body:
  s_cmp_ge_u32 s2, 256
  s_cbranch_scc1 p1_pf
  v_lshrrev_b32 v1, 6, v0
  v_and_b32 v0, 63, v0
  v_readfirstlane_b32 s20, v1
  v_lshlrev_b32 v123, 4, v0
  v_lshrrev_b32 v2, 2, v1
  v_and_b32 v3, 3, v1
  v_lshlrev_b32 v3, 1, v3
  v_lshl_add_u32 v2, v2, 4, v3
  v_lshrrev_b32 v4, 5, v0
  v_lshl_add_u32 v2, v4, 3, v2
  v_cvt_f32_u32 v2, v2
  v_lshrrev_b32 v3, 1, v1
  v_and_b32 v5, 1, v1
  v_lshlrev_b32 v5, 1, v5
  v_lshl_add_u32 v3, v3, 3, v5
  v_lshl_add_u32 v3, v4, 2, v3
  v_cvt_f32_u32 v3, v3
  v_and_b32 v4, 31, v0
  v_cvt_f32_u32 v4, v4
  v_mul_f32 v5, 0x3d000000, v4
  v_mul_f32 v6, v5, v2
  v_add_f32 v7, v6, v5
  v_cos_f32 v86, v6
  v_cos_f32 v87, v7
  v_sin_f32 v88, v6
  v_sin_f32 v89, v7
  v_mul_f32 v5, 0x3a800000, v4
  v_mul_f32 v6, v5, v3
  v_add_f32 v7, v6, v5
  v_cos_f32 v106, v6
  v_sin_f32 v107, v6
  v_cos_f32 v108, v7
  v_sin_f32 v109, v7
  v_cvt_pk_bf16_f32 v102, v86, v87
  v_cvt_pk_bf16_f32 v103, -v88, -v89
  v_bfe_u32 v4, v0, 1, 4
  v_cvt_f32_u32 v4, v4
  v_mul_f32 v5, 0x3d000000, v4
  v_and_b32 v6, 1, v0
  v_cvt_f32_u32 v6, v6
  v_mul_f32 v6, 0.25, v6
  v_fma_f32 v6, v5, v3, v6
  v_add_f32 v7, v6, v5
  v_cos_f32 v86, v6
  v_sin_f32 v87, v6
  v_cos_f32 v88, v7
  v_sin_f32 v89, v7
  s_lshl_b32 s23, s20, 8
  s_add_u32 s23, s23, s2
  s_lshl_b32 s23, s23, 11
  v_cvt_pk_bf16_f32 v104, v86, v87
  v_cvt_pk_bf16_f32 v105, v88, v89
  s_waitcnt lgkmcnt(0)
  s_add_u32 s40, s36, 0x400000
  s_addc_u32 s41, s37, 0
  s_cmp_eq_u32 s38, 0
  s_cselect_b32 s40, s32, s40
  s_cselect_b32 s41, s33, s41
  s_mov_b32 s4, s40
  s_mov_b32 s5, s41
  s_mov_b32 s6, 0x400000
  s_mov_b32 s7, 0x20000
  buffer_load_dwordx4 v[8:11], v123, s[4:7], s23 offen
  buffer_load_dwordx4 v[12:15], v123, s[4:7], s23 offen offset:1024
  s_cmp_eq_u32 s38, 0
  s_cbranch_scc1 p1_nopart
  s_add_u32 s12, s36, 0x1000000
  s_addc_u32 s13, s37, 0
  s_mov_b32 s14, 0x400000
  s_mov_b32 s15, 0x20000
  s_add_u32 s44, s23, 0
  buffer_load_dwordx4 v[16:19], v123, s[12:15], s44 offen
  buffer_load_dwordx4 v[20:23], v123, s[12:15], s44 offen offset:1024
  s_add_u32 s16, s36, 0x400000
  s_addc_u32 s17, s37, 0
  s_mov_b32 s18, 0x400000
  s_mov_b32 s19, 0x20000
p1_nopart:
  s_lshr_b32 s21, s20, 2
  s_lshl_b32 s21, s21, 10
  s_and_b32 s22, s20, 3
  s_lshl_b32 s22, s22, 2
  s_add_u32 s21, s21, s22
  v_add_u32 v1, s21, v123
  ds_write_b32 v1, v102
  ds_write_b32 v1, v103 offset:2048
  s_lshr_b32 s21, s20, 1
  s_lshl_b32 s21, s21, 10
  s_and_b32 s22, s20, 1
  s_lshl_b32 s22, s22, 3
  s_add_u32 s21, s21, s22
  v_add_u32 v1, s21, v123
  ds_write_b64 v1, v[104:105] offset:4096
  s_lshl_b32 s21, s20, 10
  v_add_u32 v1, s21, v123
  ds_write_b128 v1, v[106:109] offset:8192
  s_mov_b32 s8, s36
  s_mov_b32 s9, s37
  s_mov_b32 s10, 0x400000
  s_mov_b32 s11, 0x20000
  s_lshl_b32 s21, s20, 11
  s_add_u32 s21, s21, 16384
  v_add_u32 v119, s21, v123
  v_lshrrev_b32 v3, 5, v0
  v_bfe_u32 v4, v0, 2, 2
  v_lshl_add_u32 v3, v3, 3, v4
  v_lshlrev_b32 v3, 6, v3
  v_bfe_u32 v4, v0, 4, 1
  v_lshl_add_u32 v3, v4, 5, v3
  v_and_b32 v4, 3, v0
  v_lshl_add_u32 v3, v4, 3, v3
  v_add_u32 v120, s21, v3
  s_waitcnt lgkmcnt(0)
  s_barrier
  ds_read_b128 v[32:35], v123 offset:0
  ds_read_b128 v[36:39], v123 offset:1024
  ds_read_b128 v[40:43], v123 offset:2048
  ds_read_b128 v[44:47], v123 offset:3072
  ds_read_b128 v[48:51], v123 offset:8192
  ds_read_b128 v[52:55], v123 offset:9216
  ds_read_b128 v[56:59], v123 offset:10240
  ds_read_b128 v[60:63], v123 offset:11264
  ds_read_b128 v[64:67], v123 offset:12288
  ds_read_b128 v[68:71], v123 offset:13312
  ds_read_b128 v[72:75], v123 offset:14336
  ds_read_b128 v[76:79], v123 offset:15360
  s_lshr_b32 s21, s20, 1
  s_mul_i32 s21, s21, 4224
  s_and_b32 s22, s20, 1
  s_lshl_b32 s22, s22, 2
  s_add_u32 s21, s21, s22
  s_add_u32 s21, s21, 32768
  v_and_b32 v3, 31, v0
  v_lshrrev_b32 v4, 5, v0
  v_lshl_add_u32 v3, v4, 6, v3
  v_lshlrev_b32 v3, 3, v3
  v_add_u32 v121, s21, v3
  v_lshrrev_b32 v3, 4, v0
  v_mul_u32_u24 v3, 4224, v3
  v_and_b32 v4, 15, v0
  v_lshl_add_u32 v3, v4, 5, v3
  s_lshl_b32 s21, s20, 9
  s_add_u32 s21, s21, 32768
  v_add_u32 v122, s21, v3
  v_bfe_u32 v3, v0, 2, 2
  v_lshrrev_b32 v4, 4, v0
  v_lshlrev_b32 v3, 17, v3
  v_lshl_add_u32 v3, v4, 15, v3
  v_and_b32 v4, 3, v0
  v_lshl_add_u32 v118, v4, 4, v3
  s_and_b32 s21, s2, 7
  s_lshl_b32 s21, s21, 5
  s_lshr_b32 s22, s2, 3
  s_add_u32 s21, s21, s22
  s_lshl_b32 s21, s21, 6
  s_lshl_b32 s22, s20, 19
  s_add_u32 s21, s21, s22
  v_add_u32 v118, s21, v118
  v_bfe_u32 v1, v0, 1, 3
  v_lshrrev_b32 v2, 4, v0
  v_lshlrev_b32 v2, 1, v2
  v_and_b32 v3, 1, v0
  v_cvt_f32_u32 v3, v3
  v_mul_f32 v3, 0.25, v3
  v_add_u32 v4, 0, v2
  v_lshl_add_u32 v4, v4, 8, s2
  v_mul_u32_u24 v4, v4, v1
  v_and_b32 v4, 2047, v4
  v_cvt_f32_u32 v4, v4
  v_fmamk_f32 v4, v4, 0x3a000000, v3
  v_cos_f32 v5, v4
  v_sin_f32 v4, v4
  s_nop 0
  v_cvt_pk_bf16_f32 v80, v5, v4
  v_add_u32 v4, 1, v2
  v_lshl_add_u32 v4, v4, 8, s2
  v_mul_u32_u24 v4, v4, v1
  v_and_b32 v4, 2047, v4
  v_cvt_f32_u32 v4, v4
  v_fmamk_f32 v4, v4, 0x3a000000, v3
  v_cos_f32 v5, v4
  v_sin_f32 v4, v4
  s_nop 0
  v_cvt_pk_bf16_f32 v81, v5, v4
  s_waitcnt vmcnt(0)
  s_cmp_eq_u32 s38, 0
  s_cbranch_scc1 p1_ln
  v_lshlrev_b32 v86, 16, v8
  v_and_b32 v87, 0xffff0000, v8
  v_lshlrev_b32 v88, 16, v16
  v_and_b32 v89, 0xffff0000, v16
  v_pk_add_f32 v[86:87], v[86:87], v[88:89]
  v_cvt_pk_bf16_f32 v8, v86, v87
  v_lshlrev_b32 v94, 16, v9
  v_and_b32 v95, 0xffff0000, v9
  v_lshlrev_b32 v96, 16, v17
  v_and_b32 v97, 0xffff0000, v17
  v_pk_add_f32 v[94:95], v[94:95], v[96:97]
  v_cvt_pk_bf16_f32 v9, v94, v95
  v_lshlrev_b32 v86, 16, v10
  v_and_b32 v87, 0xffff0000, v10
  v_lshlrev_b32 v88, 16, v18
  v_and_b32 v89, 0xffff0000, v18
  v_pk_add_f32 v[86:87], v[86:87], v[88:89]
  v_cvt_pk_bf16_f32 v10, v86, v87
  v_lshlrev_b32 v94, 16, v11
  v_and_b32 v95, 0xffff0000, v11
  v_lshlrev_b32 v96, 16, v19
  v_and_b32 v97, 0xffff0000, v19
  v_pk_add_f32 v[94:95], v[94:95], v[96:97]
  v_cvt_pk_bf16_f32 v11, v94, v95
  v_lshlrev_b32 v86, 16, v12
  v_and_b32 v87, 0xffff0000, v12
  v_lshlrev_b32 v88, 16, v20
  v_and_b32 v89, 0xffff0000, v20
  v_pk_add_f32 v[86:87], v[86:87], v[88:89]
  v_cvt_pk_bf16_f32 v12, v86, v87
  v_lshlrev_b32 v94, 16, v13
  v_and_b32 v95, 0xffff0000, v13
  v_lshlrev_b32 v96, 16, v21
  v_and_b32 v97, 0xffff0000, v21
  v_pk_add_f32 v[94:95], v[94:95], v[96:97]
  v_cvt_pk_bf16_f32 v13, v94, v95
  v_lshlrev_b32 v86, 16, v14
  v_and_b32 v87, 0xffff0000, v14
  v_lshlrev_b32 v88, 16, v22
  v_and_b32 v89, 0xffff0000, v22
  v_pk_add_f32 v[86:87], v[86:87], v[88:89]
  v_cvt_pk_bf16_f32 v14, v86, v87
  v_lshlrev_b32 v94, 16, v15
  v_and_b32 v95, 0xffff0000, v15
  v_lshlrev_b32 v96, 16, v23
  v_and_b32 v97, 0xffff0000, v23
  v_pk_add_f32 v[94:95], v[94:95], v[96:97]
  v_cvt_pk_bf16_f32 v15, v94, v95
  s_cmp_eq_u32 s94, 0
  s_cbranch_scc1 p1_x2mem
  v_add_u32 v1, 114752, v119
  ds_write_b128 v1, v[8:11]
  ds_write_b128 v1, v[12:15] offset:1024
  s_branch p1_ln
p1_x2mem:
  buffer_store_dwordx4 v[8:11], v123, s[16:19], s23 offen sc1
  buffer_store_dwordx4 v[12:15], v123, s[16:19], s23 offen offset:1024 sc1
p1_ln:
  v_lshlrev_b32 v86, 16, v8
  v_and_b32 v87, 0xffff0000, v8
  v_lshlrev_b32 v88, 16, v9
  v_and_b32 v89, 0xffff0000, v9
  v_lshlrev_b32 v90, 16, v10
  v_and_b32 v91, 0xffff0000, v10
  v_lshlrev_b32 v92, 16, v11
  v_and_b32 v93, 0xffff0000, v11
  v_lshlrev_b32 v94, 16, v12
  v_and_b32 v95, 0xffff0000, v12
  v_lshlrev_b32 v96, 16, v13
  v_and_b32 v97, 0xffff0000, v13
  v_lshlrev_b32 v98, 16, v14
  v_and_b32 v99, 0xffff0000, v14
  v_lshlrev_b32 v100, 16, v15
  v_and_b32 v101, 0xffff0000, v15
  v_pk_add_f32 v[82:83], v[86:87], v[88:89]
  v_pk_mul_f32 v[84:85], v[86:87], v[86:87]
  v_pk_fma_f32 v[84:85], v[88:89], v[88:89], v[84:85]
  v_pk_add_f32 v[82:83], v[82:83], v[90:91]
  v_pk_fma_f32 v[84:85], v[90:91], v[90:91], v[84:85]
  v_pk_add_f32 v[82:83], v[82:83], v[92:93]
  v_pk_fma_f32 v[84:85], v[92:93], v[92:93], v[84:85]
  v_pk_add_f32 v[82:83], v[82:83], v[94:95]
  v_pk_fma_f32 v[84:85], v[94:95], v[94:95], v[84:85]
  v_pk_add_f32 v[82:83], v[82:83], v[96:97]
  v_pk_fma_f32 v[84:85], v[96:97], v[96:97], v[84:85]
  v_pk_add_f32 v[82:83], v[82:83], v[98:99]
  v_pk_fma_f32 v[84:85], v[98:99], v[98:99], v[84:85]
  v_pk_add_f32 v[82:83], v[82:83], v[100:101]
  v_pk_fma_f32 v[84:85], v[100:101], v[100:101], v[84:85]
  v_add_f32 v84, v84, v85
  v_add_f32_dpp v82, v82, v82 row_shr:1 row_mask:0xf bank_mask:0xf
  v_add_f32_dpp v83, v83, v83 row_shr:1 row_mask:0xf bank_mask:0xf
  v_add_f32_dpp v84, v84, v84 row_shr:1 row_mask:0xf bank_mask:0xf
  v_add_f32_dpp v82, v82, v82 row_shr:2 row_mask:0xf bank_mask:0xf
  v_add_f32_dpp v83, v83, v83 row_shr:2 row_mask:0xf bank_mask:0xf
  v_add_f32_dpp v84, v84, v84 row_shr:2 row_mask:0xf bank_mask:0xf
  v_add_f32_dpp v82, v82, v82 row_shr:4 row_mask:0xf bank_mask:0xf
  v_add_f32_dpp v83, v83, v83 row_shr:4 row_mask:0xf bank_mask:0xf
  v_add_f32_dpp v84, v84, v84 row_shr:4 row_mask:0xf bank_mask:0xf
  v_add_f32_dpp v82, v82, v82 row_shr:8 row_mask:0xf bank_mask:0xf
  v_add_f32_dpp v83, v83, v83 row_shr:8 row_mask:0xf bank_mask:0xf
  v_add_f32_dpp v84, v84, v84 row_shr:8 row_mask:0xf bank_mask:0xf
  v_add_f32_dpp v82, v82, v82 row_bcast:15 row_mask:0xa bank_mask:0xf
  v_add_f32_dpp v83, v83, v83 row_bcast:15 row_mask:0xa bank_mask:0xf
  v_add_f32_dpp v84, v84, v84 row_bcast:15 row_mask:0xa bank_mask:0xf
  v_add_f32_dpp v82, v82, v82 row_bcast:31 row_mask:0xc bank_mask:0xf
  v_add_f32_dpp v83, v83, v83 row_bcast:31 row_mask:0xc bank_mask:0xf
  v_add_f32_dpp v84, v84, v84 row_bcast:31 row_mask:0xc bank_mask:0xf
  v_readlane_b32 s24, v82, 63
  v_readlane_b32 s25, v83, 63
  v_readlane_b32 s26, v84, 63
  v_mov_b32 v84, s24
  v_add_f32 v84, s25, v84
  v_mul_f32 v84, 0xba800000, v84
  v_mov_b32 v83, 0x3727c5ac
  v_mov_b32 v82, s26
  v_fmamk_f32 v82, v82, 0x3a800000, v83
  v_fma_f32 v82, -v84, v84, v82
  v_max_f32 v82, v82, v83
  v_rsq_f32 v82, v82
  s_nop 0
  v_mul_f32 v84, v84, v82
  v_pk_fma_f32 v[86:87], v[86:87], v[82:83], v[84:85] op_sel_hi:[1,0,0]
  v_pk_fma_f32 v[88:89], v[88:89], v[82:83], v[84:85] op_sel_hi:[1,0,0]
  v_pk_fma_f32 v[90:91], v[90:91], v[82:83], v[84:85] op_sel_hi:[1,0,0]
  v_pk_fma_f32 v[92:93], v[92:93], v[82:83], v[84:85] op_sel_hi:[1,0,0]
  v_pk_fma_f32 v[94:95], v[94:95], v[82:83], v[84:85] op_sel_hi:[1,0,0]
  v_pk_fma_f32 v[96:97], v[96:97], v[82:83], v[84:85] op_sel_hi:[1,0,0]
  v_pk_fma_f32 v[98:99], v[98:99], v[82:83], v[84:85] op_sel_hi:[1,0,0]
  v_pk_fma_f32 v[100:101], v[100:101], v[82:83], v[84:85] op_sel_hi:[1,0,0]
  v_cvt_pk_bf16_f32 v16, v86, v87
  v_cvt_pk_bf16_f32 v17, v88, v89
  v_cvt_pk_bf16_f32 v18, v90, v91
  v_cvt_pk_bf16_f32 v19, v92, v93
  v_cvt_pk_bf16_f32 v20, v94, v95
  v_cvt_pk_bf16_f32 v21, v96, v97
  v_cvt_pk_bf16_f32 v22, v98, v99
  v_cvt_pk_bf16_f32 v23, v100, v101
  ds_write_b128 v119, v[16:19]
  ds_write_b128 v119, v[20:23] offset:1024
  v_mov_b32 v83, s24
  v_subrev_f32 v83, s25, v83
  v_mul_f32 v83, v83, v82
  s_waitcnt lgkmcnt(0)
  ds_read_b64_tr_b16 v[24:25], v120 offset:0
  ds_read_b64_tr_b16 v[26:27], v120 offset:256
  ds_read_b64_tr_b16 v[28:29], v120 offset:1024
  ds_read_b64_tr_b16 v[30:31], v120 offset:1280
  s_waitcnt lgkmcnt(2)
  v_mfma_f32_32x32x16_bf16 v[86:101], v[24:27], v[32:35], 0
  v_mfma_f32_32x32x16_bf16 v[102:117], v[24:27], v[40:43], 0
  s_waitcnt lgkmcnt(0)
  v_mfma_f32_32x32x16_bf16 v[86:101], v[28:31], v[36:39], v[86:101]
  v_mfma_f32_32x32x16_bf16 v[102:117], v[28:31], v[44:47], v[102:117]
  ds_read_b128 v[32:35], v123 offset:4096
  ds_read_b128 v[36:39], v123 offset:5120
  ds_read_b128 v[40:43], v123 offset:6144
  ds_read_b128 v[44:47], v123 offset:7168
  s_nop 6
  v_mul_f32 v1, v86, v48
  v_mul_f32 v24, v102, v48
  v_mul_f32 v2, v87, v50
  v_mul_f32 v25, v103, v50
  v_mul_f32 v3, v88, v52
  v_mul_f32 v26, v104, v52
  v_mul_f32 v4, v89, v54
  v_mul_f32 v27, v105, v54
  v_fma_f32 v1, v102, v49, v1
  v_fma_f32 v24, -v86, v49, v24
  v_fma_f32 v2, v103, v51, v2
  v_fma_f32 v25, -v87, v51, v25
  v_fma_f32 v3, v104, v53, v3
  v_fma_f32 v26, -v88, v53, v26
  v_fma_f32 v4, v105, v55, v4
  v_fma_f32 v27, -v89, v55, v27
  v_cvt_pk_bf16_f32 v8, v1, v24
  v_cvt_pk_bf16_f32 v9, v2, v25
  v_cvt_pk_bf16_f32 v10, v3, v26
  v_cvt_pk_bf16_f32 v11, v4, v27
  v_mul_f32 v1, v90, v56
  v_mul_f32 v24, v106, v56
  v_mul_f32 v2, v91, v58
  v_mul_f32 v25, v107, v58
  v_mul_f32 v3, v92, v60
  v_mul_f32 v26, v108, v60
  v_mul_f32 v4, v93, v62
  v_mul_f32 v27, v109, v62
  v_fma_f32 v1, v106, v57, v1
  v_fma_f32 v24, -v90, v57, v24
  v_fma_f32 v2, v107, v59, v2
  v_fma_f32 v25, -v91, v59, v25
  v_fma_f32 v3, v108, v61, v3
  v_fma_f32 v26, -v92, v61, v26
  v_fma_f32 v4, v109, v63, v4
  v_fma_f32 v27, -v93, v63, v27
  v_cvt_pk_bf16_f32 v12, v1, v24
  v_cvt_pk_bf16_f32 v13, v2, v25
  v_cvt_pk_bf16_f32 v14, v3, v26
  v_cvt_pk_bf16_f32 v15, v4, v27
  v_mul_f32 v1, v94, v64
  v_mul_f32 v24, v110, v64
  v_mul_f32 v2, v95, v66
  v_mul_f32 v25, v111, v66
  v_mul_f32 v3, v96, v68
  v_mul_f32 v26, v112, v68
  v_mul_f32 v4, v97, v70
  v_mul_f32 v27, v113, v70
  v_fma_f32 v1, v110, v65, v1
  v_fma_f32 v24, -v94, v65, v24
  v_fma_f32 v2, v111, v67, v2
  v_fma_f32 v25, -v95, v67, v25
  v_fma_f32 v3, v112, v69, v3
  v_fma_f32 v26, -v96, v69, v26
  v_fma_f32 v4, v113, v71, v4
  v_fma_f32 v27, -v97, v71, v27
  v_cvt_pk_bf16_f32 v16, v1, v24
  v_cvt_pk_bf16_f32 v17, v2, v25
  v_cvt_pk_bf16_f32 v18, v3, v26
  v_cvt_pk_bf16_f32 v19, v4, v27
  v_mul_f32 v1, v98, v72
  v_mul_f32 v24, v114, v72
  v_mul_f32 v2, v99, v74
  v_mul_f32 v25, v115, v74
  v_mul_f32 v3, v100, v76
  v_mul_f32 v26, v116, v76
  v_mul_f32 v4, v101, v78
  v_mul_f32 v27, v117, v78
  v_fma_f32 v1, v114, v73, v1
  v_fma_f32 v24, -v98, v73, v24
  v_fma_f32 v2, v115, v75, v2
  v_fma_f32 v25, -v99, v75, v25
  v_fma_f32 v3, v116, v77, v3
  v_fma_f32 v26, -v100, v77, v26
  v_fma_f32 v4, v117, v79, v4
  v_fma_f32 v27, -v101, v79, v27
  v_cvt_pk_bf16_f32 v20, v1, v24
  v_cvt_pk_bf16_f32 v21, v2, v25
  v_cvt_pk_bf16_f32 v22, v3, v26
  v_cvt_pk_bf16_f32 v23, v4, v27
  s_waitcnt lgkmcnt(0)
  v_mfma_f32_32x32x16_bf16 v[86:101], v[32:35], v[8:11], 0
  v_mfma_f32_32x32x16_bf16 v[86:101], v[36:39], v[12:15], v[86:101]
  v_mfma_f32_32x32x16_bf16 v[86:101], v[40:43], v[16:19], v[86:101]
  v_mfma_f32_32x32x16_bf16 v[86:101], v[44:47], v[20:23], v[86:101]
  s_nop 7
  s_mov_b64 exec, 1
  s_nop 2
  v_mov_b32 v86, v83
  s_mov_b64 exec, -1
  v_cvt_pk_bf16_f32 v24, v86, v87
  ds_write_b32 v121, v24 offset:0
  v_cvt_pk_bf16_f32 v25, v88, v89
  ds_write_b32 v121, v25 offset:256
  v_cvt_pk_bf16_f32 v26, v90, v91
  ds_write_b32 v121, v26 offset:1024
  v_cvt_pk_bf16_f32 v27, v92, v93
  ds_write_b32 v121, v27 offset:1280
  v_cvt_pk_bf16_f32 v28, v94, v95
  ds_write_b32 v121, v28 offset:2048
  v_cvt_pk_bf16_f32 v29, v96, v97
  ds_write_b32 v121, v29 offset:2304
  v_cvt_pk_bf16_f32 v30, v98, v99
  ds_write_b32 v121, v30 offset:3072
  v_cvt_pk_bf16_f32 v31, v100, v101
  ds_write_b32 v121, v31 offset:3328
  s_waitcnt lgkmcnt(0)
  s_barrier
  ds_read_b128 v[16:19], v122
  ds_read_b128 v[20:23], v122 offset:16
  s_mov_b32 s22, 16384
  s_waitcnt lgkmcnt(1)
  v_mfma_f32_16x16x16_bf16 v[102:105], v[80:81], v[16:17], 0
  v_mfma_f32_16x16x16_bf16 v[106:109], v[80:81], v[18:19], 0
  s_waitcnt lgkmcnt(0)
  v_mfma_f32_16x16x16_bf16 v[110:113], v[80:81], v[20:21], 0
  v_mfma_f32_16x16x16_bf16 v[114:117], v[80:81], v[22:23], 0
  s_nop 3
  v_cvt_pk_bf16_f32 v24, v102, v103
  v_cvt_pk_bf16_f32 v28, v104, v105
  v_cvt_pk_bf16_f32 v25, v106, v107
  v_cvt_pk_bf16_f32 v29, v108, v109
  v_cvt_pk_bf16_f32 v26, v110, v111
  v_cvt_pk_bf16_f32 v30, v112, v113
  v_cvt_pk_bf16_f32 v27, v114, v115
  v_cvt_pk_bf16_f32 v31, v116, v117
  buffer_store_dwordx4 v[24:27], v118, s[8:11], 0 offen sc1
  buffer_store_dwordx4 v[28:31], v118, s[8:11], s22 offen sc1
  s_cmp_eq_u32 s94, 0
  s_cbranch_scc1 p1_fin
  s_and_b32 s92, s2, 255
  s_lshl_b32 s92, s92, 7
  s_add_u32 s92, s92, 0xc08000
  s_lshr_b32 s93, s94, 1
  s_mul_i32 s93, s93, 65536
  s_add_u32 s92, s92, s93
  s_add_u32 s4, s36, s92
  s_addc_u32 s5, s37, 0
  s_mov_b32 s6, 0x80
  s_mov_b32 s7, 0x20000
  v_lshlrev_b32 v2, 8, v250
  v_mov_b32 v3, 1
  s_waitcnt vmcnt(0) lgkmcnt(0)
  s_barrier
  buffer_atomic_add v3, v2, s[4:7], 0 offen sc1
  v_mov_b32 v0, v250
  s_branch p2_fused
p1_fin:
  s_or_b32 s21, s38, s20
  s_cmp_eq_u32 s21, 0
  s_cbranch_scc0 p1_nozero
  s_and_b32 s21, s2, 255
  s_lshl_b32 s21, s21, 7
  s_add_u32 s12, s36, 0xc08000
  s_addc_u32 s13, s37, 0
  s_mov_b32 s14, 0x28000
  s_mov_b32 s15, 0x20000
  s_mov_b32 s22, 32768
  v_mul_u32_u24 v1, s22, v0
  v_add_u32 v1, s21, v1
  v_mov_b32 v2, 0
  buffer_store_dword v2, v1, s[12:15], 0 offen sc1
p1_nozero:
p1_end:
  s_endpgm
p1_pf:
  s_cmp_ge_u32 s2, 512
  s_cbranch_scc1 p1_end
  s_cmp_eq_u32 s38, 0
  s_cbranch_scc0 p1_end
  s_load_dwordx4 s[40:43], s[0:1], 8
  v_lshrrev_b32 v1, 6, v0
  v_and_b32 v0, 63, v0
  v_readfirstlane_b32 s20, v1
  s_sub_u32 s24, s2, 256
  s_cmp_ge_u32 s20, 2
  s_cbranch_scc1 p1_pf2
  s_and_b32 s25, s24, 7
  s_bfe_u32 s26, s24, 0x30003
  s_lshr_b32 s27, s24, 6
  s_lshl_b32 s28, s27, 4
  s_lshl_b32 s29, s20, 3
  s_add_u32 s28, s28, s29
  v_lshrrev_b32 v2, 3, v0
  v_add_u32 v4, s28, v2
  s_lshl_b32 s28, s27, 6
  s_add_u32 s28, s28, s29
  v_add_u32 v2, s28, v2
  v_lshl_add_u32 v2, v2, 3, s25
  v_mul_u32_u24 v2, 1026, v2
  v_and_b32 v3, 7, v0
  s_lshl_b32 s28, s26, 7
  v_add_u32 v5, s28, v2
  v_lshl_add_u32 v5, v3, 4, v5
  v_lshrrev_b32 v6, 1, v3
  v_lshlrev_b32 v6, 17, v6
  v_and_b32 v7, 1, v3
  v_lshl_add_u32 v6, v7, 13, v6
  v_lshl_add_u32 v6, v4, 4, v6
  s_lshl_b32 s28, s26, 5
  s_add_u32 s28, s28, s25
  s_lshl_b32 s28, s28, 14
  v_add_u32 v6, s28, v6
  s_waitcnt lgkmcnt(0)
  s_mov_b32 s4, s40
  s_mov_b32 s5, s41
  s_mov_b32 s6, 0x201000
  s_mov_b32 s7, 0x20000
  s_mov_b32 s8, s42
  s_mov_b32 s9, s43
  s_mov_b32 s10, 0x201000
  s_mov_b32 s11, 0x20000
  s_mov_b32 s21, 0
  buffer_load_dwordx4 v[8:11], v5, s[4:7], s21 offen
  buffer_load_dwordx4 v[24:27], v5, s[8:11], s21 offen
  s_mov_b32 s21, 131328
  buffer_load_dwordx4 v[12:15], v5, s[4:7], s21 offen
  buffer_load_dwordx4 v[28:31], v5, s[8:11], s21 offen
  s_mov_b32 s21, 262656
  buffer_load_dwordx4 v[16:19], v5, s[4:7], s21 offen
  buffer_load_dwordx4 v[32:35], v5, s[8:11], s21 offen
  s_mov_b32 s21, 393984
  buffer_load_dwordx4 v[20:23], v5, s[4:7], s21 offen
  buffer_load_dwordx4 v[36:39], v5, s[8:11], s21 offen
  s_add_u32 s12, s36, 0x1400000
  s_addc_u32 s13, s37, 0
  s_mov_b32 s14, 0x400000
  s_mov_b32 s15, 0x20000
  s_cmp_eq_u32 s26, 0
  s_cbranch_scc0 p1_nonyq
  s_mov_b32 s21, 0
  buffer_load_ushort v40, v2, s[4:7], s21 offen offset:1024
  buffer_load_ushort v44, v2, s[8:11], s21 offen offset:1024
  s_mov_b32 s21, 131328
  buffer_load_ushort v41, v2, s[4:7], s21 offen offset:1024
  buffer_load_ushort v45, v2, s[8:11], s21 offen offset:1024
  s_mov_b32 s21, 262656
  buffer_load_ushort v42, v2, s[4:7], s21 offen offset:1024
  buffer_load_ushort v46, v2, s[8:11], s21 offen offset:1024
  s_mov_b32 s21, 393984
  buffer_load_ushort v43, v2, s[4:7], s21 offen offset:1024
  buffer_load_ushort v47, v2, s[8:11], s21 offen offset:1024
  s_mov_b32 s21, 0xffff0000
  v_cmp_eq_u32 vcc, 0, v3
  s_waitcnt vmcnt(0)
  v_and_or_b32 v40, v8, s21, v40
  v_cndmask_b32 v8, v8, v40, vcc
  v_and_or_b32 v44, v24, s21, v44
  v_cndmask_b32 v24, v24, v44, vcc
  v_and_or_b32 v41, v12, s21, v41
  v_cndmask_b32 v12, v12, v41, vcc
  v_and_or_b32 v45, v28, s21, v45
  v_cndmask_b32 v28, v28, v45, vcc
  v_and_or_b32 v42, v16, s21, v42
  v_cndmask_b32 v16, v16, v42, vcc
  v_and_or_b32 v46, v32, s21, v46
  v_cndmask_b32 v32, v32, v46, vcc
  v_and_or_b32 v43, v20, s21, v43
  v_cndmask_b32 v20, v20, v43, vcc
  v_and_or_b32 v47, v36, s21, v47
  v_cndmask_b32 v36, v36, v47, vcc
p1_nonyq:
  s_mov_b32 s27, 0x05040100
  s_mov_b32 s28, 0x07060302
  v_add_u32 v7, 4096, v6
  s_waitcnt vmcnt(0)
  v_perm_b32 v48, v24, v8, s27
  v_perm_b32 v49, v28, v12, s27
  v_perm_b32 v50, v32, v16, s27
  v_perm_b32 v51, v36, v20, s27
  buffer_store_dwordx4 v[48:51], v6, s[12:15], 0 offen offset:0 sc1
  v_perm_b32 v52, v24, v8, s28
  v_perm_b32 v53, v28, v12, s28
  v_perm_b32 v54, v32, v16, s28
  v_perm_b32 v55, v36, v20, s28
  buffer_store_dwordx4 v[52:55], v6, s[12:15], 0 offen offset:1024 sc1
  v_perm_b32 v56, v25, v9, s27
  v_perm_b32 v57, v29, v13, s27
  v_perm_b32 v58, v33, v17, s27
  v_perm_b32 v59, v37, v21, s27
  buffer_store_dwordx4 v[56:59], v6, s[12:15], 0 offen offset:2048 sc1
  v_perm_b32 v60, v25, v9, s28
  v_perm_b32 v61, v29, v13, s28
  v_perm_b32 v62, v33, v17, s28
  v_perm_b32 v63, v37, v21, s28
  buffer_store_dwordx4 v[60:63], v6, s[12:15], 0 offen offset:3072 sc1
  v_perm_b32 v64, v26, v10, s27
  v_perm_b32 v65, v30, v14, s27
  v_perm_b32 v66, v34, v18, s27
  v_perm_b32 v67, v38, v22, s27
  buffer_store_dwordx4 v[64:67], v7, s[12:15], 0 offen offset:0 sc1
  v_perm_b32 v68, v26, v10, s28
  v_perm_b32 v69, v30, v14, s28
  v_perm_b32 v70, v34, v18, s28
  v_perm_b32 v71, v38, v22, s28
  buffer_store_dwordx4 v[68:71], v7, s[12:15], 0 offen offset:1024 sc1
  v_perm_b32 v72, v27, v11, s27
  v_perm_b32 v73, v31, v15, s27
  v_perm_b32 v74, v35, v19, s27
  v_perm_b32 v75, v39, v23, s27
  buffer_store_dwordx4 v[72:75], v7, s[12:15], 0 offen offset:2048 sc1
  v_perm_b32 v76, v27, v11, s28
  v_perm_b32 v77, v31, v15, s28
  v_perm_b32 v78, v35, v19, s28
  v_perm_b32 v79, v39, v23, s28
  buffer_store_dwordx4 v[76:79], v7, s[12:15], 0 offen offset:3072 sc1
  s_endpgm
p1_pf2:
  s_endpgm
.p2align 8
.globl p2a_kernel
.type p2a_kernel,@function
p2a_kernel:
  s_mov_b32 s94, 0
  s_branch p2_fused
.p2align 8
.globl p2b_kernel
.type p2b_kernel,@function
p2b_kernel:
  s_mov_b32 s94, 0
p2_fused:
  s_load_dwordx2 s[36:37], s[0:1], 72
  s_cmp_ge_u32 s2, 256
  s_cbranch_scc1 p2_pf
  v_lshrrev_b32 v1, 6, v0
  v_and_b32 v0, 63, v0
  v_readfirstlane_b32 s20, v1
  v_lshrrev_b32 v2, 3, v0
  v_lshlrev_b32 v2, 5, v2
  v_bfe_u32 v3, v0, 2, 1
  v_add_u32 v2, v2, v3
  v_lshl_add_u32 v2, v1, 2, v2
  v_lshlrev_b32 v2, 6, v2
  v_lshrrev_b32 v3, 4, v0
  v_and_b32 v4, 3, v0
  v_xor_b32 v4, v4, v3
  v_lshl_add_u32 v88, v4, 4, v2
  v_lshlrev_b32 v90, 4, v0
  v_and_b32 v2, 7, v0
  v_bfe_u32 v4, v0, 3, 1
  v_lshl_add_u32 v2, v2, 1, v4
  v_lshrrev_b32 v4, 2, v2
  v_lshrrev_b32 v5, 1, v1
  v_xor_b32 v4, v4, v5
  v_lshlrev_b32 v4, 4, v4
  v_lshl_add_u32 v4, v2, 6, v4
  v_lshl_add_u32 v4, v3, 12, v4
  v_and_b32 v5, 1, v1
  v_lshl_add_u32 v89, v5, 3, v4
  s_lshl_b32 s22, s20, 11
  s_mov_b32 m0, s22
  s_lshl_b32 s21, s2, 14
  s_add_u32 s24, s21, 0x1400000
  v_and_b32 v1, 15, v0
  v_cvt_f32_u32 v1, v1
  v_cvt_f32_u32 v2, v3
  v_mul_f32 v3, v1, v2
  v_mul_f32 v4, 0.25, v3
  v_cos_f32 v6, v4
  v_sin_f32 v7, v4
  s_nop 0
  v_cvt_pk_bf16_f32 v24, v6, v7
  v_cvt_pk_bf16_f32 v28, -v7, v6
  v_cvt_pk_bf16_f32 v32, v6, -v7
  v_cvt_pk_bf16_f32 v36, v7, v6
  v_fmamk_f32 v5, v1, 0x3d800000, v4
  v_cos_f32 v6, v5
  v_sin_f32 v7, v5
  s_nop 0
  v_cvt_pk_bf16_f32 v25, v6, v7
  v_cvt_pk_bf16_f32 v29, -v7, v6
  v_cvt_pk_bf16_f32 v33, v6, -v7
  v_cvt_pk_bf16_f32 v37, v7, v6
  s_waitcnt lgkmcnt(0)
  s_add_u32 s8, s36, s24
  s_addc_u32 s9, s37, 0
  s_mov_b32 s10, 0x4000
  s_mov_b32 s11, 0x20000
  v_lshlrev_b32 v8, 4, v0
  v_add_u32 v90, s22, v8
  buffer_load_dwordx4 v[20:23], v90, s[8:11], 0 offen offset:1024
  buffer_load_dwordx4 v[16:19], v90, s[8:11], 0 offen
  s_cmp_lg_u32 s94, 1
  s_cbranch_scc1 p2_w_go
  s_cmp_lt_u32 s20, 4
  s_cbranch_scc0 p2_w_bar
  s_lshr_b32 s92, s94, 1
  s_mul_i32 s92, s92, 65536
  s_add_u32 s92, s92, 0xc08000
  s_add_u32 s4, s36, s92
  s_addc_u32 s5, s37, 0
  s_mov_b32 s6, 0x8000
  s_mov_b32 s7, 0x20000
  v_and_b32 v8, 255, v250
  v_lshlrev_b32 v8, 7, v8
  s_mov_b32 s92, 0x10000
p2_w_poll:
  buffer_load_dword v9, v8, s[4:7], 0 offen sc1
  s_sub_u32 s92, s92, 1
  s_cmp_eq_u32 s92, 0
  s_cbranch_scc1 p2_w_bar
  s_waitcnt vmcnt(0)
  v_cmp_gt_u32 vcc, 1, v9
  s_nop 0
  s_cmp_lg_u64 vcc, 0
  s_cbranch_scc1 p2_w_poll
p2_w_bar:
  s_barrier
p2_w_go:
  s_add_u32 s4, s36, s21
  s_addc_u32 s5, s37, 0
  s_mov_b32 s6, 0x4000
  s_mov_b32 s7, 0x20000
  buffer_load_dwordx4 v88, s[4:7], 0 offen lds
  s_add_u32 m0, s22, 896
  s_add_u32 s21, s21, 0x2c00000
  buffer_load_dwordx4 v88, s[4:7], 0 offen offset:128 lds
  s_add_u32 s12, s36, s21
  s_addc_u32 s13, s37, 0
  s_mov_b32 s14, 0x4000
  s_mov_b32 s15, 0x20000
  s_cmp_eq_u32 s94, 2
  s_cbranch_scc0 p2_nostream
  s_lshl_b32 s80, s2, 13
  v_lshlrev_b32 v208, 4, v250
  v_add_u32 v208, s80, v208
  s_mov_b32 s80, s76
  s_mov_b32 s81, s77
  s_mov_b32 s82, 0x200000
  s_mov_b32 s83, 0x20000
  buffer_load_dwordx4 v[200:203], v208, s[80:83], 0 offen
  s_mov_b32 s80, s78
  s_mov_b32 s81, s79
  s_mov_b32 s82, 0x200000
  s_mov_b32 s83, 0x20000
  buffer_load_dwordx4 v[204:207], v208, s[80:83], 0 offen
p2_nostream:
  v_fmamk_f32 v5, v1, 0x3e000000, v4
  v_cos_f32 v6, v5
  v_sin_f32 v7, v5
  s_nop 0
  v_cvt_pk_bf16_f32 v26, v6, v7
  v_cvt_pk_bf16_f32 v30, -v7, v6
  v_cvt_pk_bf16_f32 v34, v6, -v7
  v_cvt_pk_bf16_f32 v38, v7, v6
  v_fmamk_f32 v5, v1, 0x3e400000, v4
  v_cos_f32 v6, v5
  v_sin_f32 v7, v5
  s_nop 0
  v_cvt_pk_bf16_f32 v27, v6, v7
  v_cvt_pk_bf16_f32 v31, -v7, v6
  v_cvt_pk_bf16_f32 v35, v6, -v7
  v_cvt_pk_bf16_f32 v39, v7, v6
  v_mul_f32 v4, 0x3c800000, v3
  v_cos_f32 v40, v4
  v_sin_f32 v44, v4
  v_fmamk_f32 v5, v1, 0x3b800000, v4
  v_cos_f32 v41, v5
  v_sin_f32 v45, v5
  v_fmamk_f32 v5, v1, 0x3c000000, v4
  v_cos_f32 v42, v5
  v_sin_f32 v46, v5
  v_fmamk_f32 v5, v1, 0x3c400000, v4
  v_cos_f32 v43, v5
  v_sin_f32 v47, v5
  s_cmp_eq_u32 s94, 2
  s_cbranch_scc1 p2_w2
  s_waitcnt vmcnt(0)
p2_w2:
  s_waitcnt vmcnt(2)
  s_barrier
  ds_read_b64 v[8:9], v89 offset:0
  ds_read_b64 v[10:11], v89 offset:1024
  ds_read_b64 v[12:13], v89 offset:2048
  ds_read_b64 v[14:15], v89 offset:3072
  s_waitcnt lgkmcnt(0)
  v_mov_b32 v48, v8
  v_mov_b32 v49, v10
  v_mov_b32 v50, v12
  v_mov_b32 v51, v14
  v_mov_b32 v52, v9
  v_mov_b32 v53, v11
  v_mov_b32 v54, v13
  v_mov_b32 v55, v15
  v_mfma_f32_16x16x32_bf16 v[56:59], v[48:51], v[24:27], 0
  v_mfma_f32_16x16x32_bf16 v[64:67], v[48:51], v[28:31], 0
  v_mfma_f32_16x16x32_bf16 v[60:63], v[52:55], v[24:27], 0
  v_mfma_f32_16x16x32_bf16 v[68:71], v[52:55], v[28:31], 0
  s_nop 4
  v_mul_f32 v72, v56, v40
  v_mul_f32 v76, v64, v40
  v_mul_f32 v73, v57, v41
  v_mul_f32 v77, v65, v41
  v_mul_f32 v74, v58, v42
  v_mul_f32 v78, v66, v42
  v_mul_f32 v75, v59, v43
  v_mul_f32 v79, v67, v43
  v_fma_f32 v72, v64, v44, v72
  v_fma_f32 v76, -v56, v44, v76
  v_fma_f32 v73, v65, v45, v73
  v_fma_f32 v77, -v57, v45, v77
  v_fma_f32 v74, v66, v46, v74
  v_fma_f32 v78, -v58, v46, v78
  v_fma_f32 v75, v67, v47, v75
  v_fma_f32 v79, -v59, v47, v79
  v_cvt_pk_bf16_f32 v48, v72, v76
  v_cvt_pk_bf16_f32 v49, v73, v77
  v_cvt_pk_bf16_f32 v50, v74, v78
  v_cvt_pk_bf16_f32 v51, v75, v79
  v_mul_f32 v72, v60, v40
  v_mul_f32 v76, v68, v40
  v_mul_f32 v73, v61, v41
  v_mul_f32 v77, v69, v41
  v_mul_f32 v74, v62, v42
  v_mul_f32 v78, v70, v42
  v_mul_f32 v75, v63, v43
  v_mul_f32 v79, v71, v43
  v_fma_f32 v72, v68, v44, v72
  v_fma_f32 v76, -v60, v44, v76
  v_fma_f32 v73, v69, v45, v73
  v_fma_f32 v77, -v61, v45, v77
  v_fma_f32 v74, v70, v46, v74
  v_fma_f32 v78, -v62, v46, v78
  v_fma_f32 v75, v71, v47, v75
  v_fma_f32 v79, -v63, v47, v79
  v_cvt_pk_bf16_f32 v52, v72, v76
  v_cvt_pk_bf16_f32 v53, v73, v77
  v_cvt_pk_bf16_f32 v54, v74, v78
  v_cvt_pk_bf16_f32 v55, v75, v79
  v_mfma_f32_16x16x32_bf16 v[56:59], v[24:27], v[48:51], 0
  v_mfma_f32_16x16x32_bf16 v[64:67], v[28:31], v[48:51], 0
  v_mfma_f32_16x16x32_bf16 v[60:63], v[24:27], v[52:55], 0
  v_mfma_f32_16x16x32_bf16 v[68:71], v[28:31], v[52:55], 0
  v_lshlrev_b32 v80, 16, v16
  v_and_b32 v84, 0xffff0000, v16
  v_lshlrev_b32 v81, 16, v17
  v_and_b32 v85, 0xffff0000, v17
  v_lshlrev_b32 v82, 16, v18
  v_and_b32 v86, 0xffff0000, v18
  v_lshlrev_b32 v83, 16, v19
  v_and_b32 v87, 0xffff0000, v19
  v_mul_f32 v72, v56, v80
  v_mul_f32 v76, v64, v80
  v_mul_f32 v73, v57, v81
  v_mul_f32 v77, v65, v81
  v_mul_f32 v74, v58, v82
  v_mul_f32 v78, v66, v82
  v_mul_f32 v75, v59, v83
  v_mul_f32 v79, v67, v83
  v_fma_f32 v72, -v64, v84, v72
  v_fma_f32 v76, v56, v84, v76
  v_fma_f32 v73, -v65, v85, v73
  v_fma_f32 v77, v57, v85, v77
  v_fma_f32 v74, -v66, v86, v74
  v_fma_f32 v78, v58, v86, v78
  v_fma_f32 v75, -v67, v87, v75
  v_fma_f32 v79, v59, v87, v79
  v_cvt_pk_bf16_f32 v48, v72, v76
  v_cvt_pk_bf16_f32 v49, v73, v77
  v_cvt_pk_bf16_f32 v50, v74, v78
  v_cvt_pk_bf16_f32 v51, v75, v79
  v_lshlrev_b32 v80, 16, v20
  v_and_b32 v84, 0xffff0000, v20
  v_lshlrev_b32 v81, 16, v21
  v_and_b32 v85, 0xffff0000, v21
  v_lshlrev_b32 v82, 16, v22
  v_and_b32 v86, 0xffff0000, v22
  v_lshlrev_b32 v83, 16, v23
  v_and_b32 v87, 0xffff0000, v23
  v_mul_f32 v72, v60, v80
  v_mul_f32 v76, v68, v80
  v_mul_f32 v73, v61, v81
  v_mul_f32 v77, v69, v81
  v_mul_f32 v74, v62, v82
  v_mul_f32 v78, v70, v82
  v_mul_f32 v75, v63, v83
  v_mul_f32 v79, v71, v83
  v_fma_f32 v72, -v68, v84, v72
  v_fma_f32 v76, v60, v84, v76
  v_fma_f32 v73, -v69, v85, v73
  v_fma_f32 v77, v61, v85, v77
  v_fma_f32 v74, -v70, v86, v74
  v_fma_f32 v78, v62, v86, v78
  v_fma_f32 v75, -v71, v87, v75
  v_fma_f32 v79, v63, v87, v79
  v_cvt_pk_bf16_f32 v52, v72, v76
  v_cvt_pk_bf16_f32 v53, v73, v77
  v_cvt_pk_bf16_f32 v54, v74, v78
  v_cvt_pk_bf16_f32 v55, v75, v79
  v_mfma_f32_16x16x32_bf16 v[56:59], v[48:51], v[32:35], 0
  v_mfma_f32_16x16x32_bf16 v[64:67], v[48:51], v[36:39], 0
  v_mfma_f32_16x16x32_bf16 v[60:63], v[52:55], v[32:35], 0
  v_mfma_f32_16x16x32_bf16 v[68:71], v[52:55], v[36:39], 0
  s_nop 4
  v_mul_f32 v72, v56, v40
  v_mul_f32 v76, v64, v40
  v_mul_f32 v73, v57, v41
  v_mul_f32 v77, v65, v41
  v_mul_f32 v74, v58, v42
  v_mul_f32 v78, v66, v42
  v_mul_f32 v75, v59, v43
  v_mul_f32 v79, v67, v43
  v_fma_f32 v72, -v64, v44, v72
  v_fma_f32 v76, v56, v44, v76
  v_fma_f32 v73, -v65, v45, v73
  v_fma_f32 v77, v57, v45, v77
  v_fma_f32 v74, -v66, v46, v74
  v_fma_f32 v78, v58, v46, v78
  v_fma_f32 v75, -v67, v47, v75
  v_fma_f32 v79, v59, v47, v79
  v_cvt_pk_bf16_f32 v48, v72, v76
  v_cvt_pk_bf16_f32 v49, v73, v77
  v_cvt_pk_bf16_f32 v50, v74, v78
  v_cvt_pk_bf16_f32 v51, v75, v79
  v_mul_f32 v72, v60, v40
  v_mul_f32 v76, v68, v40
  v_mul_f32 v73, v61, v41
  v_mul_f32 v77, v69, v41
  v_mul_f32 v74, v62, v42
  v_mul_f32 v78, v70, v42
  v_mul_f32 v75, v63, v43
  v_mul_f32 v79, v71, v43
  v_fma_f32 v72, -v68, v44, v72
  v_fma_f32 v76, v60, v44, v76
  v_fma_f32 v73, -v69, v45, v73
  v_fma_f32 v77, v61, v45, v77
  v_fma_f32 v74, -v70, v46, v74
  v_fma_f32 v78, v62, v46, v78
  v_fma_f32 v75, -v71, v47, v75
  v_fma_f32 v79, v63, v47, v79
  v_cvt_pk_bf16_f32 v52, v72, v76
  v_cvt_pk_bf16_f32 v53, v73, v77
  v_cvt_pk_bf16_f32 v54, v74, v78
  v_cvt_pk_bf16_f32 v55, v75, v79
  v_mfma_f32_16x16x32_bf16 v[56:59], v[32:35], v[48:51], 0
  v_mfma_f32_16x16x32_bf16 v[64:67], v[36:39], v[48:51], 0
  v_mfma_f32_16x16x32_bf16 v[60:63], v[32:35], v[52:55], 0
  v_mfma_f32_16x16x32_bf16 v[68:71], v[36:39], v[52:55], 0
  s_nop 5
  v_cvt_pk_bf16_f32 v8, v56, v64
  s_nop 0
  v_cvt_pk_bf16_f32 v9, v60, v68
  ds_write_b64 v89, v[8:9] offset:0
  v_cvt_pk_bf16_f32 v10, v57, v65
  v_cvt_pk_bf16_f32 v11, v61, v69
  ds_write_b64 v89, v[10:11] offset:1024
  v_cvt_pk_bf16_f32 v12, v58, v66
  v_cvt_pk_bf16_f32 v13, v62, v70
  ds_write_b64 v89, v[12:13] offset:2048
  v_cvt_pk_bf16_f32 v14, v59, v67
  v_cvt_pk_bf16_f32 v15, v63, v71
  ds_write_b64 v89, v[14:15] offset:3072
  s_waitcnt lgkmcnt(0)
  s_barrier
  ds_read_b128 v[48:51], v90
  ds_read_b128 v[52:55], v90 offset:1024
  s_waitcnt lgkmcnt(1)
  buffer_store_dwordx4 v[48:51], v88, s[12:15], 0 offen sc1
  s_waitcnt lgkmcnt(0)
  buffer_store_dwordx4 v[52:55], v88, s[12:15], 0 offen offset:128 sc1
  s_cmp_eq_u32 s94, 0
  s_cbranch_scc1 p2_fin
  s_and_b32 s92, s2, 255
  s_lshl_b32 s92, s92, 7
  s_add_u32 s92, s92, 0xc10000
  s_lshr_b32 s93, s94, 1
  s_mul_i32 s93, s93, 65536
  s_add_u32 s92, s92, s93
  s_add_u32 s4, s36, s92
  s_addc_u32 s5, s37, 0
  s_mov_b32 s6, 0x80
  s_mov_b32 s7, 0x20000
  v_lshlrev_b32 v2, 8, v250
  v_mov_b32 v3, 1
  s_waitcnt vmcnt(0) lgkmcnt(0)
  s_barrier
  buffer_atomic_add v3, v2, s[4:7], 0 offen sc1
  v_mov_b32 v0, v250
  s_branch p3_fused
p2_fin:
p2_end:
  s_endpgm
p2_pf:
  s_cmp_ge_u32 s2, 512
  s_cbranch_scc1 p2_end
  s_load_dwordx2 s[40:41], s[0:1], 32
  s_load_dwordx2 s[42:43], s[0:1], 40
  s_sub_u32 s20, s2, 256
  s_lshl_b32 s20, s20, 13
  v_lshlrev_b32 v1, 4, v0
  v_add_u32 v1, s20, v1
  s_waitcnt lgkmcnt(0)
  s_mov_b32 s4, s40
  s_mov_b32 s5, s41
  s_mov_b32 s6, 0x200000
  s_mov_b32 s7, 0x20000
  s_mov_b32 s21, 0
  buffer_load_dwordx4 v[4:7], v1, s[4:7], s21 offen
  s_mov_b32 s4, s42
  s_mov_b32 s5, s43
  s_mov_b32 s6, 0x200000
  s_mov_b32 s7, 0x20000
  s_mov_b32 s21, 0
  buffer_load_dwordx4 v[8:11], v1, s[4:7], s21 offen
  s_branch p2_end
.p2align 8
.globl p3a_kernel
.type p3a_kernel,@function
p3a_kernel:
  s_load_dwordx2 s[36:37], s[0:1], 72
  s_load_dwordx2 s[32:33], s[0:1], 0
  s_mov_b32 s38, 0
  s_mov_b32 s94, 0
  s_branch p3_body
.p2align 8
.globl p3b_kernel
.type p3b_kernel,@function
p3b_kernel:
  s_load_dwordx2 s[36:37], s[0:1], 72
  s_load_dwordx2 s[32:33], s[0:1], 0
  s_mov_b32 s38, 1
  s_mov_b32 s94, 0
  s_branch p3_body
p3_fused:
  s_load_dwordx2 s[36:37], s[0:1], 72
  s_load_dwordx2 s[32:33], s[0:1], 0
  s_and_b32 s38, s94, 1
p3_body:
  s_cmp_ge_u32 s2, 256
  s_cbranch_scc1 p3_pf
  v_lshrrev_b32 v1, 6, v0
  v_and_b32 v0, 63, v0
  v_readfirstlane_b32 s20, v1
  v_lshlrev_b32 v124, 4, v0
  v_bfe_u32 v3, v0, 2, 2
  v_lshrrev_b32 v4, 4, v0
  v_lshlrev_b32 v3, 17, v3
  v_lshl_add_u32 v3, v4, 15, v3
  v_and_b32 v4, 3, v0
  v_lshl_add_u32 v118, v4, 4, v3
  s_and_b32 s21, s2, 7
  s_lshl_b32 s21, s21, 5
  s_lshr_b32 s22, s2, 3
  s_add_u32 s21, s21, s22
  s_lshl_b32 s21, s21, 6
  s_lshl_b32 s22, s20, 19
  s_add_u32 s21, s21, s22
  v_add_u32 v118, s21, v118
  v_lshrrev_b32 v2, 2, v1
  v_and_b32 v3, 3, v1
  v_lshl_add_u32 v2, v2, 3, v3
  v_lshrrev_b32 v4, 5, v0
  v_lshl_add_u32 v2, v4, 2, v2
  v_cvt_f32_u32 v2, v2
  v_lshrrev_b32 v3, 1, v1
  v_and_b32 v5, 1, v1
  v_lshlrev_b32 v5, 1, v5
  v_lshl_add_u32 v3, v3, 3, v5
  v_lshl_add_u32 v3, v4, 2, v3
  v_cvt_f32_u32 v3, v3
  v_bfe_u32 v5, v0, 2, 1
  v_and_b32 v6, 3, v0
  v_lshl_add_u32 v6, v5, 4, v6
  v_bfe_u32 v5, v0, 3, 2
  v_lshl_add_u32 v6, v5, 2, v6
  v_cvt_f32_u32 v6, v6
  v_mul_f32 v5, 0x3d000000, v6
  v_mul_f32 v5, v5, v2
  v_cos_f32 v86, v5
  v_sin_f32 v87, v5
  v_mul_f32 v5, 0x3a800000, v6
  v_mul_f32 v6, v5, v3
  v_add_f32 v7, v6, v5
  v_cos_f32 v106, v6
  v_sin_f32 v107, v6
  v_cos_f32 v108, v7
  v_sin_f32 v109, v7
  v_cvt_pk_bf16_f32 v102, v86, -v87
  v_cvt_pk_bf16_f32 v103, v87, v86
  v_and_b32 v2, 31, v0
  v_lshlrev_b32 v5, 6, v2
  v_lshl_add_u32 v119, v4, 5, v5
  s_lshl_b32 s23, s20, 8
  s_add_u32 s23, s23, s2
  s_lshl_b32 s23, s23, 11
  s_mov_b32 s22, 16384
  s_waitcnt lgkmcnt(0)
  s_add_u32 s8, s36, 0x2c00000
  s_addc_u32 s9, s37, 0
  s_mov_b32 s10, 0x400000
  s_mov_b32 s11, 0x20000
  s_cmp_eq_u32 s94, 0
  s_cbranch_scc0 p3_xonly
  buffer_load_dwordx4 v[8:11], v118, s[8:11], 0 offen
  buffer_load_dwordx4 v[12:15], v118, s[8:11], s22 offen
p3_xonly:
  s_cmp_eq_u32 s94, 1
  s_cbranch_scc1 p3_later
  s_add_u32 s40, s36, 0x400000
  s_addc_u32 s41, s37, 0
  s_cmp_eq_u32 s38, 0
  s_cselect_b32 s40, s32, s40
  s_cselect_b32 s41, s33, s41
  s_mov_b32 s4, s40
  s_mov_b32 s5, s41
  s_mov_b32 s6, 0x400000
  s_mov_b32 s7, 0x20000
  buffer_load_dwordx4 v[24:27], v119, s[4:7], s23 offen
  buffer_load_dwordx4 v[28:31], v119, s[4:7], s23 offen offset:16
p3_later:
  v_cvt_f32_u32 v5, v2
  v_mul_f32 v5, 0x3d000000, v5
  v_mul_f32 v6, v5, v3
  v_add_f32 v7, v6, v5
  v_cos_f32 v86, v6
  v_sin_f32 v87, v6
  v_cos_f32 v88, v7
  v_sin_f32 v89, v7
  s_lshr_b32 s21, s20, 2
  s_lshl_b32 s21, s21, 10
  s_and_b32 s22, s20, 3
  s_lshl_b32 s22, s22, 2
  s_add_u32 s21, s21, s22
  v_add_u32 v1, s21, v124
  ds_write_b32 v1, v102
  ds_write_b32 v1, v103 offset:2048
  v_cvt_pk_bf16_f32 v104, v86, -v87
  v_cvt_pk_bf16_f32 v105, v88, -v89
  s_lshr_b32 s21, s20, 1
  s_lshl_b32 s21, s21, 10
  s_and_b32 s22, s20, 1
  s_lshl_b32 s22, s22, 3
  s_add_u32 s21, s21, s22
  v_add_u32 v1, s21, v124
  ds_write_b64 v1, v[104:105] offset:4096
  s_lshl_b32 s21, s20, 10
  v_add_u32 v1, s21, v124
  ds_write_b128 v1, v[106:109] offset:8192
  v_lshl_add_u32 v3, v4, 7, v2
  v_lshlrev_b32 v3, 2, v3
  s_mul_i32 s21, s20, 2112
  s_add_u32 s21, s21, 16384
  v_add_u32 v122, s21, v3
  v_lshrrev_b32 v3, 4, v0
  v_mul_u32_u24 v5, 4224, v3
  v_and_b32 v6, 15, v0
  v_lshl_add_u32 v5, v6, 4, v5
  s_lshl_b32 s21, s20, 8
  s_add_u32 s21, s21, 16384
  v_add_u32 v121, s21, v5
  v_lshlrev_b32 v5, 6, v6
  v_lshl_add_u32 v120, v3, 4, v5
  s_and_b32 s21, s2, 7
  s_lshl_b32 s21, s21, 5
  s_lshr_b32 s22, s2, 3
  s_add_u32 s21, s21, s22
  s_lshr_b32 s22, s21, 2
  s_sub_u32 s22, 0, s22
  s_and_b32 s22, s22, 3
  v_xor_b32 v3, s22, v3
  v_lshlrev_b32 v3, 4, v3
  v_lshl_add_u32 v3, v6, 14, v3
  s_lshl_b32 s21, s21, 6
  s_lshl_b32 s22, s20, 19
  s_add_u32 s21, s21, s22
  v_add_u32 v123, s21, v3
  s_lshl_b32 s21, s2, 7
  s_add_u32 s21, s21, 0xc00000
  s_add_u32 s12, s36, s21
  s_addc_u32 s13, s37, 0
  s_mov_b32 s14, 0x80
  s_mov_b32 s15, 0x20000
  v_lshlrev_b32 v1, 2, v0
  s_lshl_b32 s21, s20, 16
  v_add_u32 v1, s21, v1
  v_mov_b32 v2, 0
  buffer_store_dword v2, v1, s[12:15], 0 offen sc1
  v_bfe_u32 v1, v0, 1, 3
  v_lshrrev_b32 v2, 4, v0
  v_lshlrev_b32 v2, 1, v2
  v_and_b32 v3, 1, v0
  v_cvt_f32_u32 v3, v3
  v_mul_f32 v3, 0.25, v3
  v_add_u32 v5, 0, v2
  v_lshl_add_u32 v4, v1, 8, s2
  v_mul_u32_u24 v4, v4, v5
  v_and_b32 v4, 2047, v4
  v_cvt_f32_u32 v4, v4
  v_fmamk_f32 v4, v4, 0xba000000, v3
  v_cos_f32 v5, v4
  v_sin_f32 v4, v4
  v_mul_f32 v5, 0x35800000, v5
  v_mul_f32 v4, 0x35800000, v4
  v_cvt_pk_bf16_f32 v80, v5, v4
  v_add_u32 v5, 1, v2
  v_lshl_add_u32 v4, v1, 8, s2
  v_mul_u32_u24 v4, v4, v5
  v_and_b32 v4, 2047, v4
  v_cvt_f32_u32 v4, v4
  v_fmamk_f32 v4, v4, 0xba000000, v3
  v_cos_f32 v5, v4
  v_sin_f32 v4, v4
  v_mul_f32 v5, 0x35800000, v5
  v_mul_f32 v4, 0x35800000, v4
  v_cvt_pk_bf16_f32 v81, v5, v4
  s_mul_i32 s21, s38, 46137344
  s_add_u32 s21, s21, 0x400000
  s_add_u32 s12, s36, s21
  s_addc_u32 s13, s37, 0
  s_mov_b32 s14, 0x400000
  s_mov_b32 s15, 0x20000
  s_add_u32 s16, s36, 0x800000
  s_addc_u32 s17, s37, 0
  s_mov_b32 s18, 0x400000
  s_mov_b32 s19, 0x20000
  s_cmp_eq_u32 s94, 0
  s_cbranch_scc1 p3_w_go
  s_cmp_eq_u32 s94, 2
  s_cbranch_scc1 p3_nostash
  s_lshl_b32 s21, s20, 11
  s_add_u32 s21, s21, 131136
  v_add_u32 v1, s21, v119
  ds_read_b128 v[24:27], v1
  ds_read_b128 v[28:31], v1 offset:16
p3_nostash:
  s_cmp_eq_u32 s94, 0
  s_cbranch_scc1 p3_w2_go
  s_cmp_lt_u32 s20, 4
  s_cbranch_scc0 p3_w2_bar
  s_lshr_b32 s92, s94, 1
  s_mul_i32 s92, s92, 65536
  s_add_u32 s92, s92, 0xc10000
  s_add_u32 s4, s36, s92
  s_addc_u32 s5, s37, 0
  s_mov_b32 s6, 0x8000
  s_mov_b32 s7, 0x20000
  v_and_b32 v2, 255, v250
  v_lshlrev_b32 v2, 7, v2
  s_mov_b32 s92, 0x10000
p3_w2_poll:
  buffer_load_dword v3, v2, s[4:7], 0 offen sc1
  s_sub_u32 s92, s92, 1
  s_cmp_eq_u32 s92, 0
  s_cbranch_scc1 p3_w2_bar
  s_waitcnt vmcnt(0)
  v_cmp_gt_u32 vcc, 1, v3
  s_nop 0
  s_cmp_lg_u64 vcc, 0
  s_cbranch_scc1 p3_w2_poll
p3_w2_bar:
  s_barrier
p3_w2_go:
  s_mov_b32 s22, 16384
  buffer_load_dwordx4 v[8:11], v118, s[8:11], 0 offen
  buffer_load_dwordx4 v[12:15], v118, s[8:11], s22 offen
  s_cmp_eq_u32 s94, 2
  s_cbranch_scc1 p3_w3
  s_waitcnt vmcnt(0)
p3_w3:
  s_cmp_eq_u32 s94, 2
  s_cbranch_scc0 p3_nostream
  s_lshl_b32 s80, s2, 13
  v_lshlrev_b32 v208, 4, v250
  v_add_u32 v208, s80, v208
  s_add_u32 s80, s76, 0x200000
  s_addc_u32 s81, s77, 0
  s_mov_b32 s82, 0x100000
  s_mov_b32 s83, 0x20000
  buffer_load_dwordx4 v[200:203], v208, s[80:83], 0 offen
  s_add_u32 s80, s78, 0x200000
  s_addc_u32 s81, s79, 0
  s_mov_b32 s82, 0x100000
  s_mov_b32 s83, 0x20000
  buffer_load_dwordx4 v[204:207], v208, s[80:83], 0 offen
p3_nostream:
  s_waitcnt vmcnt(2)
p3_w_go:
  s_waitcnt vmcnt(3)
  v_mov_b32 v16, v8
  v_mov_b32 v17, v12
  v_mov_b32 v18, v9
  v_mov_b32 v19, v13
  v_mov_b32 v20, v10
  v_mov_b32 v21, v14
  v_mov_b32 v22, v11
  v_mov_b32 v23, v15
  v_mfma_f32_16x16x16_bf16 v[86:89], v[80:81], v[16:17], 0
  v_mfma_f32_16x16x16_bf16 v[90:93], v[80:81], v[18:19], 0
  v_mfma_f32_16x16x16_bf16 v[94:97], v[80:81], v[20:21], 0
  v_mfma_f32_16x16x16_bf16 v[98:101], v[80:81], v[22:23], 0
  s_nop 4
  v_cvt_pk_bf16_f32 v8, v86, v87
  v_cvt_pk_bf16_f32 v12, v88, v89
  v_cvt_pk_bf16_f32 v9, v90, v91
  v_cvt_pk_bf16_f32 v13, v92, v93
  v_cvt_pk_bf16_f32 v10, v94, v95
  v_cvt_pk_bf16_f32 v14, v96, v97
  v_cvt_pk_bf16_f32 v11, v98, v99
  v_cvt_pk_bf16_f32 v15, v100, v101
  ds_write_b128 v121, v[8:11]
  ds_write_b128 v121, v[12:15] offset:2112
  v_add_u32 v7, 1024, v122
  s_waitcnt lgkmcnt(0)
  s_barrier
  ds_read2_b32 v[16:17], v122 offset0:0 offset1:32
  ds_read2_b32 v[18:19], v122 offset0:64 offset1:96
  ds_read2_b32 v[20:21], v7 offset0:0 offset1:32
  ds_read2_b32 v[22:23], v7 offset0:64 offset1:96
  ds_read_b128 v[32:35], v124 offset:0
  ds_read_b128 v[40:43], v124 offset:2048
  ds_read_b128 v[36:39], v124 offset:1024
  ds_read_b128 v[44:47], v124 offset:3072
  ds_read_b128 v[48:51], v124 offset:8192
  ds_read_b128 v[52:55], v124 offset:9216
  ds_read_b128 v[56:59], v124 offset:10240
  ds_read_b128 v[60:63], v124 offset:11264
  ds_read_b128 v[64:67], v124 offset:12288
  ds_read_b128 v[68:71], v124 offset:13312
  ds_read_b128 v[72:75], v124 offset:14336
  ds_read_b128 v[76:79], v124 offset:15360
  s_waitcnt lgkmcnt(12)
  v_readlane_b32 s24, v16, 0
  v_writelane_b32 v16, 0, 0
  s_waitcnt lgkmcnt(10)
  s_nop 0
  v_mfma_f32_32x32x16_bf16 v[86:101], v[16:19], v[32:35], 0
  v_mfma_f32_32x32x16_bf16 v[102:117], v[16:19], v[40:43], 0
  s_waitcnt lgkmcnt(8)
  v_mfma_f32_32x32x16_bf16 v[86:101], v[20:23], v[36:39], v[86:101]
  v_mfma_f32_32x32x16_bf16 v[102:117], v[20:23], v[44:47], v[102:117]
  ds_read_b128 v[32:35], v124 offset:4096
  ds_read_b128 v[36:39], v124 offset:5120
  ds_read_b128 v[40:43], v124 offset:6144
  ds_read_b128 v[44:47], v124 offset:7168
  s_lshl_b32 s24, s24, 16
  v_mul_f32_e64 v5, 0.5, s24
  s_waitcnt lgkmcnt(4)
  s_nop 3
  v_mul_f32 v1, v86, v48
  v_mul_f32 v82, v102, v48
  v_mul_f32 v2, v87, v50
  v_mul_f32 v83, v103, v50
  v_mul_f32 v3, v88, v52
  v_mul_f32 v84, v104, v52
  v_mul_f32 v4, v89, v54
  v_mul_f32 v85, v105, v54
  v_fma_f32 v1, -v102, v49, v1
  v_fma_f32 v82, v86, v49, v82
  v_fma_f32 v2, -v103, v51, v2
  v_fma_f32 v83, v87, v51, v83
  v_fma_f32 v3, -v104, v53, v3
  v_fma_f32 v84, v88, v53, v84
  v_fma_f32 v4, -v105, v55, v4
  v_fma_f32 v85, v89, v55, v85
  v_cvt_pk_bf16_f32 v8, v1, v82
  v_cvt_pk_bf16_f32 v9, v2, v83
  v_cvt_pk_bf16_f32 v10, v3, v84
  v_cvt_pk_bf16_f32 v11, v4, v85
  v_mul_f32 v1, v90, v56
  v_mul_f32 v82, v106, v56
  v_mul_f32 v2, v91, v58
  v_mul_f32 v83, v107, v58
  v_mul_f32 v3, v92, v60
  v_mul_f32 v84, v108, v60
  v_mul_f32 v4, v93, v62
  v_mul_f32 v85, v109, v62
  v_fma_f32 v1, -v106, v57, v1
  v_fma_f32 v82, v90, v57, v82
  v_fma_f32 v2, -v107, v59, v2
  v_fma_f32 v83, v91, v59, v83
  v_fma_f32 v3, -v108, v61, v3
  v_fma_f32 v84, v92, v61, v84
  v_fma_f32 v4, -v109, v63, v4
  v_fma_f32 v85, v93, v63, v85
  v_cvt_pk_bf16_f32 v12, v1, v82
  v_cvt_pk_bf16_f32 v13, v2, v83
  v_cvt_pk_bf16_f32 v14, v3, v84
  v_cvt_pk_bf16_f32 v15, v4, v85
  v_mov_b32 v48, v5
  v_sub_f32 v49, 0, v5
  v_mov_b32 v50, v5
  v_sub_f32 v51, 0, v5
  v_mov_b32 v52, v5
  v_sub_f32 v53, 0, v5
  v_mov_b32 v54, v5
  v_sub_f32 v55, 0, v5
  v_mov_b32 v56, v5
  v_sub_f32 v57, 0, v5
  v_mov_b32 v58, v5
  v_sub_f32 v59, 0, v5
  v_mov_b32 v60, v5
  v_sub_f32 v61, 0, v5
  v_mov_b32 v62, v5
  v_sub_f32 v63, 0, v5
  v_mul_f32 v1, v94, v64
  v_mul_f32 v82, v110, v64
  v_mul_f32 v2, v95, v66
  v_mul_f32 v83, v111, v66
  v_mul_f32 v3, v96, v68
  v_mul_f32 v84, v112, v68
  v_mul_f32 v4, v97, v70
  v_mul_f32 v85, v113, v70
  v_fma_f32 v1, -v110, v65, v1
  v_fma_f32 v82, v94, v65, v82
  v_fma_f32 v2, -v111, v67, v2
  v_fma_f32 v83, v95, v67, v83
  v_fma_f32 v3, -v112, v69, v3
  v_fma_f32 v84, v96, v69, v84
  v_fma_f32 v4, -v113, v71, v4
  v_fma_f32 v85, v97, v71, v85
  v_cvt_pk_bf16_f32 v16, v1, v82
  v_cvt_pk_bf16_f32 v17, v2, v83
  v_cvt_pk_bf16_f32 v18, v3, v84
  v_cvt_pk_bf16_f32 v19, v4, v85
  v_mul_f32 v1, v98, v72
  v_mul_f32 v82, v114, v72
  v_mul_f32 v2, v99, v74
  v_mul_f32 v83, v115, v74
  v_mul_f32 v3, v100, v76
  v_mul_f32 v84, v116, v76
  v_mul_f32 v4, v101, v78
  v_mul_f32 v85, v117, v78
  v_fma_f32 v1, -v114, v73, v1
  v_fma_f32 v82, v98, v73, v82
  v_fma_f32 v2, -v115, v75, v2
  v_fma_f32 v83, v99, v75, v83
  v_fma_f32 v3, -v116, v77, v3
  v_fma_f32 v84, v100, v77, v84
  v_fma_f32 v4, -v117, v79, v4
  v_fma_f32 v85, v101, v79, v85
  v_cvt_pk_bf16_f32 v20, v1, v82
  v_cvt_pk_bf16_f32 v21, v2, v83
  v_cvt_pk_bf16_f32 v22, v3, v84
  v_cvt_pk_bf16_f32 v23, v4, v85
  s_waitcnt lgkmcnt(0)
  v_mfma_f32_32x32x16_bf16 v[48:63], v[8:11], v[32:35], v[48:63]
  v_mfma_f32_32x32x16_bf16 v[48:63], v[12:15], v[36:39], v[48:63]
  v_mfma_f32_32x32x16_bf16 v[48:63], v[16:19], v[40:43], v[48:63]
  v_mfma_f32_32x32x16_bf16 v[48:63], v[20:23], v[44:47], v[48:63]
  s_cmp_eq_u32 s94, 2
  s_cbranch_scc1 p3_w4
  s_waitcnt vmcnt(0)
p3_w4:
  v_lshlrev_b32 v86, 16, v24
  v_and_b32 v87, 0xffff0000, v24
  v_lshlrev_b32 v88, 16, v25
  v_and_b32 v89, 0xffff0000, v25
  v_lshlrev_b32 v90, 16, v26
  v_and_b32 v91, 0xffff0000, v26
  v_lshlrev_b32 v92, 16, v27
  v_and_b32 v93, 0xffff0000, v27
  v_lshlrev_b32 v94, 16, v28
  v_and_b32 v95, 0xffff0000, v28
  v_lshlrev_b32 v96, 16, v29
  v_and_b32 v97, 0xffff0000, v29
  v_lshlrev_b32 v98, 16, v30
  v_and_b32 v99, 0xffff0000, v30
  v_lshlrev_b32 v100, 16, v31
  v_and_b32 v101, 0xffff0000, v31
  v_cvt_pk_bf16_f32 v8, v48, v49
  v_cvt_pk_bf16_f32 v9, v50, v51
  v_cvt_pk_bf16_f32 v10, v52, v53
  v_cvt_pk_bf16_f32 v11, v54, v55
  v_cvt_pk_bf16_f32 v12, v56, v57
  v_cvt_pk_bf16_f32 v13, v58, v59
  v_cvt_pk_bf16_f32 v14, v60, v61
  v_cvt_pk_bf16_f32 v15, v62, v63
  v_lshlrev_b32 v48, 16, v8
  v_and_b32 v49, 0xffff0000, v8
  v_lshlrev_b32 v50, 16, v9
  v_and_b32 v51, 0xffff0000, v9
  v_lshlrev_b32 v52, 16, v10
  v_and_b32 v53, 0xffff0000, v10
  v_lshlrev_b32 v54, 16, v11
  v_and_b32 v55, 0xffff0000, v11
  v_lshlrev_b32 v56, 16, v12
  v_and_b32 v57, 0xffff0000, v12
  v_lshlrev_b32 v58, 16, v13
  v_and_b32 v59, 0xffff0000, v13
  v_lshlrev_b32 v60, 16, v14
  v_and_b32 v61, 0xffff0000, v14
  v_lshlrev_b32 v62, 16, v15
  v_and_b32 v63, 0xffff0000, v15
  v_pk_add_f32 v[86:87], v[86:87], v[48:49]
  v_pk_add_f32 v[88:89], v[88:89], v[50:51]
  v_pk_add_f32 v[90:91], v[90:91], v[52:53]
  v_pk_add_f32 v[92:93], v[92:93], v[54:55]
  v_pk_add_f32 v[94:95], v[94:95], v[56:57]
  v_pk_add_f32 v[96:97], v[96:97], v[58:59]
  v_pk_add_f32 v[98:99], v[98:99], v[60:61]
  v_pk_add_f32 v[100:101], v[100:101], v[62:63]
  v_cvt_pk_bf16_f32 v24, v86, v87
  v_cvt_pk_bf16_f32 v25, v88, v89
  v_cvt_pk_bf16_f32 v26, v90, v91
  v_cvt_pk_bf16_f32 v27, v92, v93
  v_cvt_pk_bf16_f32 v28, v94, v95
  v_cvt_pk_bf16_f32 v29, v96, v97
  v_cvt_pk_bf16_f32 v30, v98, v99
  v_cvt_pk_bf16_f32 v31, v100, v101
  v_lshlrev_b32 v86, 16, v24
  v_and_b32 v87, 0xffff0000, v24
  v_lshlrev_b32 v88, 16, v25
  v_and_b32 v89, 0xffff0000, v25
  v_lshlrev_b32 v90, 16, v26
  v_and_b32 v91, 0xffff0000, v26
  v_lshlrev_b32 v92, 16, v27
  v_and_b32 v93, 0xffff0000, v27
  v_lshlrev_b32 v94, 16, v28
  v_and_b32 v95, 0xffff0000, v28
  v_lshlrev_b32 v96, 16, v29
  v_and_b32 v97, 0xffff0000, v29
  v_lshlrev_b32 v98, 16, v30
  v_and_b32 v99, 0xffff0000, v30
  v_lshlrev_b32 v100, 16, v31
  v_and_b32 v101, 0xffff0000, v31
  v_permlane16_swap_b32 v24, v28
  v_permlane16_swap_b32 v25, v29
  v_permlane16_swap_b32 v26, v30
  v_permlane16_swap_b32 v27, v31
  buffer_store_dwordx4 v[24:27], v120, s[12:15], s23 offen sc1
  buffer_store_dwordx4 v[28:31], v120, s[12:15], s23 offen offset:1024 sc1
  v_pk_add_f32 v[82:83], v[86:87], v[88:89]
  v_pk_mul_f32 v[84:85], v[86:87], v[86:87]
  v_pk_fma_f32 v[84:85], v[88:89], v[88:89], v[84:85]
  v_pk_add_f32 v[82:83], v[82:83], v[90:91]
  v_pk_fma_f32 v[84:85], v[90:91], v[90:91], v[84:85]
  v_pk_add_f32 v[82:83], v[82:83], v[92:93]
  v_pk_fma_f32 v[84:85], v[92:93], v[92:93], v[84:85]
  v_pk_add_f32 v[82:83], v[82:83], v[94:95]
  v_pk_fma_f32 v[84:85], v[94:95], v[94:95], v[84:85]
  v_pk_add_f32 v[82:83], v[82:83], v[96:97]
  v_pk_fma_f32 v[84:85], v[96:97], v[96:97], v[84:85]
  v_pk_add_f32 v[82:83], v[82:83], v[98:99]
  v_pk_fma_f32 v[84:85], v[98:99], v[98:99], v[84:85]
  v_pk_add_f32 v[82:83], v[82:83], v[100:101]
  v_pk_fma_f32 v[84:85], v[100:101], v[100:101], v[84:85]
  v_add_f32 v84, v84, v85
  v_add_f32 v82, v82, v83
  s_nop 1
  v_add_f32_dpp v82, v82, v82 row_shr:1 row_mask:0xf bank_mask:0xf
  v_add_f32_dpp v84, v84, v84 row_shr:1 row_mask:0xf bank_mask:0xf
  s_nop 0
  v_add_f32_dpp v82, v82, v82 row_shr:2 row_mask:0xf bank_mask:0xf
  v_add_f32_dpp v84, v84, v84 row_shr:2 row_mask:0xf bank_mask:0xf
  s_nop 0
  v_add_f32_dpp v82, v82, v82 row_shr:4 row_mask:0xf bank_mask:0xf
  v_add_f32_dpp v84, v84, v84 row_shr:4 row_mask:0xf bank_mask:0xf
  s_nop 0
  v_add_f32_dpp v82, v82, v82 row_shr:8 row_mask:0xf bank_mask:0xf
  v_add_f32_dpp v84, v84, v84 row_shr:8 row_mask:0xf bank_mask:0xf
  s_nop 0
  v_add_f32_dpp v82, v82, v82 row_bcast:15 row_mask:0xa bank_mask:0xf
  v_add_f32_dpp v84, v84, v84 row_bcast:15 row_mask:0xa bank_mask:0xf
  s_nop 0
  v_add_f32_dpp v82, v82, v82 row_bcast:31 row_mask:0xc bank_mask:0xf
  v_add_f32_dpp v84, v84, v84 row_bcast:31 row_mask:0xc bank_mask:0xf
  v_readlane_b32 s24, v82, 63
  v_readlane_b32 s26, v84, 63
  s_mov_b32 s25, 0
  v_mov_b32 v84, s24
  v_add_f32 v84, s25, v84
  v_mul_f32 v84, 0xba800000, v84
  v_mov_b32 v83, 0x3727c5ac
  v_mov_b32 v82, s26
  v_fmamk_f32 v82, v82, 0x3a800000, v83
  v_fma_f32 v82, -v84, v84, v82
  v_max_f32 v82, v82, v83
  v_rsq_f32 v82, v82
  s_nop 0
  v_mul_f32 v84, v84, v82
  v_pk_fma_f32 v[86:87], v[86:87], v[82:83], v[84:85] op_sel_hi:[1,0,0]
  v_pk_fma_f32 v[88:89], v[88:89], v[82:83], v[84:85] op_sel_hi:[1,0,0]
  v_pk_fma_f32 v[90:91], v[90:91], v[82:83], v[84:85] op_sel_hi:[1,0,0]
  v_pk_fma_f32 v[92:93], v[92:93], v[82:83], v[84:85] op_sel_hi:[1,0,0]
  v_pk_fma_f32 v[94:95], v[94:95], v[82:83], v[84:85] op_sel_hi:[1,0,0]
  v_pk_fma_f32 v[96:97], v[96:97], v[82:83], v[84:85] op_sel_hi:[1,0,0]
  v_pk_fma_f32 v[98:99], v[98:99], v[82:83], v[84:85] op_sel_hi:[1,0,0]
  v_pk_fma_f32 v[100:101], v[100:101], v[82:83], v[84:85] op_sel_hi:[1,0,0]
  v_cvt_pk_bf16_f32 v8, v86, v87
  v_cvt_pk_bf16_f32 v9, v88, v89
  v_cvt_pk_bf16_f32 v10, v94, v95
  v_cvt_pk_bf16_f32 v11, v96, v97
  v_cvt_pk_bf16_f32 v12, v90, v91
  v_cvt_pk_bf16_f32 v13, v92, v93
  v_cvt_pk_bf16_f32 v14, v98, v99
  v_cvt_pk_bf16_f32 v15, v100, v101
  s_mov_b32 s21, 262144
  v_permlane16_swap_b32 v8, v12
  v_permlane16_swap_b32 v9, v13
  v_permlane16_swap_b32 v10, v14
  v_permlane16_swap_b32 v11, v15
  buffer_store_dwordx4 v[8:11], v123, s[16:19], 0 offen sc1
  buffer_store_dwordx4 v[12:15], v123, s[16:19], s21 offen sc1
  s_cmp_eq_u32 s94, 0
  s_cbranch_scc1 p3_fin
  s_and_b32 s92, s2, 255
  s_lshl_b32 s92, s92, 7
  s_add_u32 s92, s92, 0xc18000
  s_lshr_b32 s93, s94, 1
  s_mul_i32 s93, s93, 65536
  s_add_u32 s92, s92, s93
  s_add_u32 s4, s36, s92
  s_addc_u32 s5, s37, 0
  s_mov_b32 s6, 0x80
  s_mov_b32 s7, 0x20000
  v_lshlrev_b32 v2, 8, v250
  v_mov_b32 v3, 1
  s_waitcnt vmcnt(0) lgkmcnt(0)
  s_barrier
  buffer_atomic_add v3, v2, s[4:7], 0 offen sc1
  v_mov_b32 v0, v250
  s_branch mlp_fused
p3_fin:
p3_end:
  s_endpgm
p3_pf:
  s_cmp_ge_u32 s2, 512
  s_cbranch_scc1 p3_end
  s_load_dwordx2 s[40:41], s[0:1], 32
  s_load_dwordx2 s[42:43], s[0:1], 40
  s_sub_u32 s20, s2, 256
  s_lshl_b32 s20, s20, 13
  v_lshlrev_b32 v1, 4, v0
  v_add_u32 v1, s20, v1
  s_waitcnt lgkmcnt(0)
  s_add_u32 s4, s40, 0x200000
  s_addc_u32 s5, s41, 0
  s_mov_b32 s6, 0x300000
  s_mov_b32 s7, 0x20000
  s_mov_b32 s21, 0
  buffer_load_dwordx4 v[4:7], v1, s[4:7], s21 offen
  s_mov_b32 s21, 2097152
  buffer_load_dwordx4 v[8:11], v1, s[4:7], s21 offen
  s_add_u32 s4, s42, 0x200000
  s_addc_u32 s5, s43, 0
  s_mov_b32 s6, 0x300000
  s_mov_b32 s7, 0x20000
  s_mov_b32 s21, 0
  buffer_load_dwordx4 v[12:15], v1, s[4:7], s21 offen
  s_mov_b32 s21, 2097152
  buffer_load_dwordx4 v[16:19], v1, s[4:7], s21 offen
  s_branch p3_end
.p2align 8
.globl mlpa_kernel
.type mlpa_kernel,@function
mlpa_kernel:
  s_mov_b32 s85, 0
  s_mov_b32 s94, 0
  s_branch mlp_body
.p2align 8
.globl mlpb_kernel
.type mlpb_kernel,@function
mlpb_kernel:
  s_mov_b32 s85, 1
  s_mov_b32 s94, 0
  s_branch mlp_body
mlp_fused:
  s_and_b32 s85, s94, 1
mlp_body:
  s_cmp_ge_u32 s2, 256
  s_cbranch_scc1 mlp_end
  s_load_dwordx4 s[32:35], s[0:1], 32
  s_load_dwordx2 s[36:37], s[0:1], 72
  s_load_dwordx4 s[44:47], s[0:1], 48
  v_lshrrev_b32 v209, 6, v0
  v_and_b32 v208, 63, v0
  v_readfirstlane_b32 s20, v209
  s_and_b32 s29, s2, 7
  s_lshr_b32 s30, s2, 3
  s_and_b32 s21, s29, 1
  s_lshl_b32 s21, s21, 2
  s_and_b32 s31, s30, 3
  s_add_u32 s21, s21, s31
  s_lshr_b32 s22, s29, 1
  s_lshl_b32 s22, s22, 3
  s_lshr_b32 s31, s30, 2
  s_add_u32 s22, s22, s31
  s_lshl_b32 s25, s20, 11
  v_lshlrev_b32 v206, 4, v208
  v_add_u32 v206, s25, v206
  s_lshl_b32 s29, s20, 6
  v_add_u32 v209, s29, v208
  v_mul_u32_u24 v210, 4682, v209
  v_lshrrev_b32 v210, 16, v210
  v_mul_u32_u24 v211, 14, v210
  v_sub_u32 v211, v209, v211
  v_mul_u32_u24 v210, 7168, v210
  v_lshl_add_u32 v207, v211, 4, v210
  s_mul_i32 s29, s22, 224
  s_lshl_b32 s26, s20, 10
  s_add_u32 s27, s26, 23568
  s_add_u32 s26, s26, 16384
  s_cmp_eq_u32 s20, 7
  s_cselect_b32 s29, 0x40000000, s29
  s_cselect_b32 s26, 30752, s26
  s_cselect_b32 s27, 30752, s27
  v_add_u32 v207, s29, v207
  s_lshl_b32 s29, s21, 19
  s_add_u32 s29, s29, 0x800000
  s_waitcnt lgkmcnt(0)
  s_add_u32 s4, s36, s29
  s_addc_u32 s5, s37, 0
  s_mov_b32 s6, 0x80000
  s_mov_b32 s7, 0x20000
  s_mov_b32 s8, s32
  s_mov_b32 s9, s33
  s_mov_b32 s10, 0x700000
  s_mov_b32 s11, 0x20000
  s_mov_b32 s12, s34
  s_mov_b32 s13, s35
  s_mov_b32 s14, 0x700000
  s_mov_b32 s15, 0x20000
  s_add_u32 s16, s36, 0x1800000
  s_addc_u32 s17, s37, 0
  s_mov_b32 s18, 0xe00000
  s_mov_b32 s19, 0x20000
  s_mov_b32 s23, 0
  s_mov_b32 s24, 0
  s_mov_b32 s91, 229376
  s_add_u32 m0, s26, 0
  s_nop 0
  buffer_load_dwordx4 v207, s[8:11], s24 offen lds
  s_add_u32 m0, s27, 0
  s_nop 0
  buffer_load_dwordx4 v207, s[12:15], s24 offen lds
  s_add_u32 s24, s24, s91
  s_add_u32 m0, s26, 31776
  s_nop 0
  buffer_load_dwordx4 v207, s[8:11], s24 offen lds
  s_add_u32 m0, s27, 31776
  s_nop 0
  buffer_load_dwordx4 v207, s[12:15], s24 offen lds
  s_add_u32 s24, s24, s91
  v_and_b32 v209, 15, v208
  v_lshrrev_b32 v210, 4, v208
  v_lshrrev_b32 v211, 2, v209
  v_sub_u32 v212, 0, v211
  v_and_b32 v212, 3, v212
  v_xor_b32 v212, v212, v210
  v_lshlrev_b32 v212, 4, v212
  v_lshl_add_u32 v200, v209, 6, v212
  s_and_b32 s29, s20, 3
  s_lshl_b32 s29, s29, 12
  v_add_u32 v200, s29, v200
  v_lshrrev_b32 v212, 1, v210
  v_lshl_add_u32 v211, v212, 4, v211
  v_and_b32 v212, 1, v210
  v_lshl_add_u32 v211, v212, 2, v211
  v_mul_u32_u24 v211, 224, v211
  s_lshr_b32 s29, s20, 2
  s_mul_i32 s29, s29, 112
  v_add_u32 v211, s29, v211
  v_and_b32 v212, 3, v208
  v_lshl_add_u32 v202, v212, 3, v211
  v_and_b32 v212, 1, v208
  v_lshl_add_u32 v204, v212, 3, v211
  v_bfe_u32 v212, v208, 1, 1
  v_mul_u32_u24 v212, 7184, v212
  v_add_u32 v204, v204, v212
  v_add_u32 v201, 63552, v200
  v_add_u32 v203, 63552, v202
  v_add_u32 v205, 63552, v204
  s_cmp_eq_u32 s94, 0
  s_cbranch_scc1 mlp_w_go
  s_cmp_lt_u32 s20, 4
  s_cbranch_scc0 mlp_w_bar
  s_lshr_b32 s92, s94, 1
  s_mul_i32 s92, s92, 65536
  s_add_u32 s92, s92, 0xc18000
  s_add_u32 s40, s36, s92
  s_addc_u32 s41, s37, 0
  s_mov_b32 s42, 0x8000
  s_mov_b32 s43, 0x20000
  v_and_b32 v209, 255, v250
  v_lshlrev_b32 v209, 7, v209
  s_mov_b32 s92, 0x10000
mlp_w_poll:
  buffer_load_dword v210, v209, s[40:43], 0 offen sc1
  s_sub_u32 s92, s92, 1
  s_cmp_eq_u32 s92, 0
  s_cbranch_scc1 mlp_w_bar
  s_waitcnt vmcnt(0)
  v_cmp_gt_u32 vcc, 1, v210
  s_nop 0
  s_cmp_lg_u64 vcc, 0
  s_cbranch_scc1 mlp_w_poll
mlp_w_bar:
  s_barrier
mlp_w_go:
  s_add_u32 m0, s25, 0
  s_nop 0
  buffer_load_dwordx4 v206, s[4:7], s23 offen lds
  buffer_load_dwordx4 v206, s[4:7], s23 offen offset:1024 lds
  s_add_u32 s23, s23, 16384
  s_add_u32 m0, s25, 31776
  s_nop 0
  buffer_load_dwordx4 v206, s[4:7], s23 offen lds
  buffer_load_dwordx4 v206, s[4:7], s23 offen offset:1024 lds
  s_add_u32 s23, s23, 16384
  s_lshl_b32 s29, s85, 3
  s_add_u32 s29, s29, s20
  s_cmp_eq_u32 s29, 7
  s_cbranch_scc0 mlp_nopf
  s_lshr_b32 s29, s2, 1
  s_lshl_b32 s29, s29, 10
  v_lshlrev_b32 v207, 4, v208
  v_add_u32 v207, s29, v207
  s_mov_b32 s24, 0
  s_mov_b32 s91, 0x20000
  s_bitcmp1_b32 s2, 0
  s_cbranch_scc1 mlp_pfodd
  s_mov_b32 s8, s44
  s_mov_b32 s9, s45
  s_mov_b32 s10, 0x380000
  s_mov_b32 s11, 0x20000
  s_add_u32 s12, s32, 0x300000
  s_addc_u32 s13, s33, 0
  s_mov_b32 s14, 0x400000
  s_mov_b32 s15, 0x20000
  s_branch mlp_nopf
mlp_pfodd:
  s_add_u32 s8, s44, 0x380000
  s_addc_u32 s9, s45, 0
  s_mov_b32 s10, 0x380000
  s_mov_b32 s11, 0x20000
  s_add_u32 s12, s34, 0x300000
  s_addc_u32 s13, s35, 0
  s_mov_b32 s14, 0x400000
  s_mov_b32 s15, 0x20000
mlp_nopf:
  s_waitcnt vmcnt(2)
  s_barrier
  ds_read_b128 v[112:115], v200 offset:0
  ds_read_b128 v[116:119], v200 offset:1024
  ds_read_b128 v[120:123], v200 offset:2048
  ds_read_b128 v[124:127], v200 offset:3072
  ds_read_b64_tr_b16 v[144:145], v202 offset:16384
  ds_read_b64_tr_b16 v[146:147], v202 offset:18176
  ds_read_b64_tr_b16 v[148:149], v202 offset:23568
  ds_read_b64_tr_b16 v[150:151], v202 offset:25360
  ds_read_b64_tr_b16 v[152:153], v202 offset:16416
  ds_read_b64_tr_b16 v[154:155], v202 offset:18208
  ds_read_b64_tr_b16 v[156:157], v202 offset:23600
  ds_read_b64_tr_b16 v[158:159], v202 offset:25392
  ds_read_b64_tr_b16 v[160:161], v202 offset:16448
  ds_read_b64_tr_b16 v[162:163], v202 offset:18240
  ds_read_b64_tr_b16 v[164:165], v202 offset:23632
  ds_read_b64_tr_b16 v[166:167], v202 offset:25424
  ds_read_b64_tr_b16 v[168:169], v204 offset:16480
  ds_read_b64_tr_b16 v[170:171], v204 offset:18272
  s_waitcnt lgkmcnt(0)
  v_mfma_f32_16x16x32_bf16 v[0:3], v[144:147], v[112:115], 0
  s_add_u32 m0, s25, 63552
  s_nop 0
  buffer_load_dwordx4 v206, s[4:7], s23 offen lds
  v_mfma_f32_16x16x32_bf16 v[28:31], v[144:147], v[116:119], 0
  buffer_load_dwordx4 v206, s[4:7], s23 offen offset:1024 lds
  s_add_u32 s23, s23, 16384
  v_mfma_f32_16x16x32_bf16 v[56:59], v[144:147], v[120:123], 0
  v_mfma_f32_16x16x32_bf16 v[84:87], v[144:147], v[124:127], 0
  s_add_u32 m0, s26, 63552
  s_nop 0
  buffer_load_dwordx4 v207, s[8:11], s24 offen lds
  v_mfma_f32_16x16x32_bf16 v[88:91], v[148:151], v[124:127], 0
  s_add_u32 m0, s27, 63552
  s_nop 0
  buffer_load_dwordx4 v207, s[12:15], s24 offen lds
  s_add_u32 s24, s24, s91
  v_mfma_f32_16x16x32_bf16 v[60:63], v[148:151], v[120:123], 0
  v_mfma_f32_16x16x32_bf16 v[32:35], v[148:151], v[116:119], 0
  s_add_u32 m0, s25, 95328
  s_nop 0
  buffer_load_dwordx4 v206, s[4:7], s23 offen lds
  v_mfma_f32_16x16x32_bf16 v[4:7], v[148:151], v[112:115], 0
  buffer_load_dwordx4 v206, s[4:7], s23 offen offset:1024 lds
  s_add_u32 s23, s23, 16384
  v_mfma_f32_16x16x32_bf16 v[8:11], v[152:155], v[112:115], 0
  v_mfma_f32_16x16x32_bf16 v[36:39], v[152:155], v[116:119], 0
  s_add_u32 m0, s26, 95328
  s_nop 0
  buffer_load_dwordx4 v207, s[8:11], s24 offen lds
  v_mfma_f32_16x16x32_bf16 v[64:67], v[152:155], v[120:123], 0
  s_add_u32 m0, s27, 95328
  s_nop 0
  buffer_load_dwordx4 v207, s[12:15], s24 offen lds
  s_add_u32 s24, s24, s91
  v_mfma_f32_16x16x32_bf16 v[92:95], v[152:155], v[124:127], 0
  s_waitcnt vmcnt(8)
  s_barrier
  v_mfma_f32_16x16x32_bf16 v[96:99], v[156:159], v[124:127], 0
  ds_read_b128 v[128:131], v200 offset:31776
  ds_read_b128 v[132:135], v200 offset:32800
  v_mfma_f32_16x16x32_bf16 v[68:71], v[156:159], v[120:123], 0
  ds_read_b128 v[136:139], v200 offset:33824
  ds_read_b128 v[140:143], v200 offset:34848
  v_mfma_f32_16x16x32_bf16 v[40:43], v[156:159], v[116:119], 0
  ds_read_b64_tr_b16 v[172:173], v202 offset:48160
  ds_read_b64_tr_b16 v[174:175], v202 offset:49952
  v_mfma_f32_16x16x32_bf16 v[12:15], v[156:159], v[112:115], 0
  ds_read_b64_tr_b16 v[176:177], v202 offset:55344
  v_mfma_f32_16x16x32_bf16 v[16:19], v[160:163], v[112:115], 0
  ds_read_b64_tr_b16 v[178:179], v202 offset:57136
  s_add_u32 m0, s25, 0
  s_nop 0
  buffer_load_dwordx4 v206, s[4:7], s23 offen lds
  v_mfma_f32_16x16x32_bf16 v[44:47], v[160:163], v[116:119], 0
  ds_read_b64_tr_b16 v[180:181], v202 offset:48192
  v_mfma_f32_16x16x32_bf16 v[72:75], v[160:163], v[120:123], 0
  ds_read_b64_tr_b16 v[182:183], v202 offset:49984
  v_mfma_f32_16x16x32_bf16 v[100:103], v[160:163], v[124:127], 0
  ds_read_b64_tr_b16 v[184:185], v202 offset:55376
  buffer_load_dwordx4 v206, s[4:7], s23 offen offset:1024 lds
  s_add_u32 s23, s23, 16384
  v_mfma_f32_16x16x32_bf16 v[104:107], v[164:167], v[124:127], 0
  ds_read_b64_tr_b16 v[186:187], v202 offset:57168
  v_mfma_f32_16x16x32_bf16 v[76:79], v[164:167], v[120:123], 0
  ds_read_b64_tr_b16 v[188:189], v202 offset:48224
  v_mfma_f32_16x16x32_bf16 v[48:51], v[164:167], v[116:119], 0
  ds_read_b64_tr_b16 v[190:191], v202 offset:50016
  s_add_u32 m0, s26, 0
  s_nop 0
  buffer_load_dwordx4 v207, s[8:11], s24 offen lds
  v_mfma_f32_16x16x32_bf16 v[20:23], v[164:167], v[112:115], 0
  ds_read_b64_tr_b16 v[192:193], v202 offset:55408
  v_mfma_f32_16x16x32_bf16 v[24:27], v[168:171], v[112:115], 0
  ds_read_b64_tr_b16 v[194:195], v202 offset:57200
  v_mfma_f32_16x16x32_bf16 v[52:55], v[168:171], v[116:119], 0
  ds_read_b64_tr_b16 v[196:197], v204 offset:48256
  s_add_u32 m0, s27, 0
  s_nop 0
  buffer_load_dwordx4 v207, s[12:15], s24 offen lds
  s_add_u32 s24, s24, s91
  v_mfma_f32_16x16x32_bf16 v[80:83], v[168:171], v[120:123], 0
  ds_read_b64_tr_b16 v[198:199], v204 offset:50048
  v_mfma_f32_16x16x32_bf16 v[108:111], v[168:171], v[124:127], 0
  s_mov_b32 s28, 7
.p2align 6
mlp_loop:
  s_waitcnt vmcnt(8) lgkmcnt(0)
  s_barrier
  v_mfma_f32_16x16x32_bf16 v[0:3], v[172:175], v[128:131], v[0:3]
  ds_read_b128 v[112:115], v201 offset:0
  v_mfma_f32_16x16x32_bf16 v[28:31], v[172:175], v[132:135], v[28:31]
  ds_read_b128 v[116:119], v201 offset:1024
  v_mfma_f32_16x16x32_bf16 v[56:59], v[172:175], v[136:139], v[56:59]
  s_add_u32 m0, s25, 31776
  s_nop 0
  buffer_load_dwordx4 v206, s[4:7], s23 offen lds
  ds_read_b128 v[120:123], v201 offset:2048
  v_mfma_f32_16x16x32_bf16 v[84:87], v[172:175], v[140:143], v[84:87]
  ds_read_b128 v[124:127], v201 offset:3072
  v_mfma_f32_16x16x32_bf16 v[88:91], v[176:179], v[140:143], v[88:91]
  ds_read_b64_tr_b16 v[144:145], v203 offset:16384
  v_mfma_f32_16x16x32_bf16 v[60:63], v[176:179], v[136:139], v[60:63]
  ds_read_b64_tr_b16 v[146:147], v203 offset:18176
  v_mfma_f32_16x16x32_bf16 v[32:35], v[176:179], v[132:135], v[32:35]
  ds_read_b64_tr_b16 v[148:149], v203 offset:23568
  v_mfma_f32_16x16x32_bf16 v[4:7], v[176:179], v[128:131], v[4:7]
  ds_read_b64_tr_b16 v[150:151], v203 offset:25360
  v_mfma_f32_16x16x32_bf16 v[8:11], v[180:183], v[128:131], v[8:11]
  ds_read_b64_tr_b16 v[152:153], v203 offset:16416
  v_mfma_f32_16x16x32_bf16 v[36:39], v[180:183], v[132:135], v[36:39]
  buffer_load_dwordx4 v206, s[4:7], s23 offen offset:1024 lds
  s_add_u32 s23, s23, 16384
  ds_read_b64_tr_b16 v[154:155], v203 offset:18208
  v_mfma_f32_16x16x32_bf16 v[64:67], v[180:183], v[136:139], v[64:67]
  ds_read_b64_tr_b16 v[156:157], v203 offset:23600
  v_mfma_f32_16x16x32_bf16 v[92:95], v[180:183], v[140:143], v[92:95]
  ds_read_b64_tr_b16 v[158:159], v203 offset:25392
  v_mfma_f32_16x16x32_bf16 v[96:99], v[184:187], v[140:143], v[96:99]
  ds_read_b64_tr_b16 v[160:161], v203 offset:16448
  v_mfma_f32_16x16x32_bf16 v[68:71], v[184:187], v[136:139], v[68:71]
  ds_read_b64_tr_b16 v[162:163], v203 offset:18240
  v_mfma_f32_16x16x32_bf16 v[40:43], v[184:187], v[132:135], v[40:43]
  ds_read_b64_tr_b16 v[164:165], v203 offset:23632
  v_mfma_f32_16x16x32_bf16 v[12:15], v[184:187], v[128:131], v[12:15]
  ds_read_b64_tr_b16 v[166:167], v203 offset:25424
  v_mfma_f32_16x16x32_bf16 v[16:19], v[188:191], v[128:131], v[16:19]
  s_add_u32 m0, s26, 31776
  s_nop 0
  buffer_load_dwordx4 v207, s[8:11], s24 offen lds
  ds_read_b64_tr_b16 v[168:169], v205 offset:16480
  v_mfma_f32_16x16x32_bf16 v[44:47], v[188:191], v[132:135], v[44:47]
  ds_read_b64_tr_b16 v[170:171], v205 offset:18272
  v_mfma_f32_16x16x32_bf16 v[72:75], v[188:191], v[136:139], v[72:75]
  v_mfma_f32_16x16x32_bf16 v[100:103], v[188:191], v[140:143], v[100:103]
  v_mfma_f32_16x16x32_bf16 v[104:107], v[192:195], v[140:143], v[104:107]
  v_mfma_f32_16x16x32_bf16 v[76:79], v[192:195], v[136:139], v[76:79]
  v_mfma_f32_16x16x32_bf16 v[48:51], v[192:195], v[132:135], v[48:51]
  v_mfma_f32_16x16x32_bf16 v[20:23], v[192:195], v[128:131], v[20:23]
  s_add_u32 m0, s27, 31776
  s_nop 0
  buffer_load_dwordx4 v207, s[12:15], s24 offen lds
  s_add_u32 s24, s24, s91
  v_mfma_f32_16x16x32_bf16 v[24:27], v[196:199], v[128:131], v[24:27]
  v_mfma_f32_16x16x32_bf16 v[52:55], v[196:199], v[132:135], v[52:55]
  v_mfma_f32_16x16x32_bf16 v[80:83], v[196:199], v[136:139], v[80:83]
  v_mfma_f32_16x16x32_bf16 v[108:111], v[196:199], v[140:143], v[108:111]
  s_waitcnt vmcnt(8) lgkmcnt(0)
  s_barrier
  v_mfma_f32_16x16x32_bf16 v[0:3], v[144:147], v[112:115], v[0:3]
  ds_read_b128 v[128:131], v201 offset:31776
  v_mfma_f32_16x16x32_bf16 v[28:31], v[144:147], v[116:119], v[28:31]
  ds_read_b128 v[132:135], v201 offset:32800
  v_mfma_f32_16x16x32_bf16 v[56:59], v[144:147], v[120:123], v[56:59]
  s_add_u32 m0, s25, 63552
  s_nop 0
  buffer_load_dwordx4 v206, s[4:7], s23 offen lds
  ds_read_b128 v[136:139], v201 offset:33824
  v_mfma_f32_16x16x32_bf16 v[84:87], v[144:147], v[124:127], v[84:87]
  ds_read_b128 v[140:143], v201 offset:34848
  v_mfma_f32_16x16x32_bf16 v[88:91], v[148:151], v[124:127], v[88:91]
  ds_read_b64_tr_b16 v[172:173], v203 offset:48160
  v_mfma_f32_16x16x32_bf16 v[60:63], v[148:151], v[120:123], v[60:63]
  ds_read_b64_tr_b16 v[174:175], v203 offset:49952
  v_mfma_f32_16x16x32_bf16 v[32:35], v[148:151], v[116:119], v[32:35]
  ds_read_b64_tr_b16 v[176:177], v203 offset:55344
  v_mfma_f32_16x16x32_bf16 v[4:7], v[148:151], v[112:115], v[4:7]
  ds_read_b64_tr_b16 v[178:179], v203 offset:57136
  v_mfma_f32_16x16x32_bf16 v[8:11], v[152:155], v[112:115], v[8:11]
  ds_read_b64_tr_b16 v[180:181], v203 offset:48192
  v_mfma_f32_16x16x32_bf16 v[36:39], v[152:155], v[116:119], v[36:39]
  buffer_load_dwordx4 v206, s[4:7], s23 offen offset:1024 lds
  s_add_u32 s23, s23, 16384
  ds_read_b64_tr_b16 v[182:183], v203 offset:49984
  v_mfma_f32_16x16x32_bf16 v[64:67], v[152:155], v[120:123], v[64:67]
  ds_read_b64_tr_b16 v[184:185], v203 offset:55376
  v_mfma_f32_16x16x32_bf16 v[92:95], v[152:155], v[124:127], v[92:95]
  ds_read_b64_tr_b16 v[186:187], v203 offset:57168
  v_mfma_f32_16x16x32_bf16 v[96:99], v[156:159], v[124:127], v[96:99]
  ds_read_b64_tr_b16 v[188:189], v203 offset:48224
  v_mfma_f32_16x16x32_bf16 v[68:71], v[156:159], v[120:123], v[68:71]
  ds_read_b64_tr_b16 v[190:191], v203 offset:50016
  v_mfma_f32_16x16x32_bf16 v[40:43], v[156:159], v[116:119], v[40:43]
  ds_read_b64_tr_b16 v[192:193], v203 offset:55408
  v_mfma_f32_16x16x32_bf16 v[12:15], v[156:159], v[112:115], v[12:15]
  ds_read_b64_tr_b16 v[194:195], v203 offset:57200
  v_mfma_f32_16x16x32_bf16 v[16:19], v[160:163], v[112:115], v[16:19]
  s_add_u32 m0, s26, 63552
  s_nop 0
  buffer_load_dwordx4 v207, s[8:11], s24 offen lds
  ds_read_b64_tr_b16 v[196:197], v205 offset:48256
  v_mfma_f32_16x16x32_bf16 v[44:47], v[160:163], v[116:119], v[44:47]
  ds_read_b64_tr_b16 v[198:199], v205 offset:50048
  v_mfma_f32_16x16x32_bf16 v[72:75], v[160:163], v[120:123], v[72:75]
  v_mfma_f32_16x16x32_bf16 v[100:103], v[160:163], v[124:127], v[100:103]
  v_mfma_f32_16x16x32_bf16 v[104:107], v[164:167], v[124:127], v[104:107]
  v_mfma_f32_16x16x32_bf16 v[76:79], v[164:167], v[120:123], v[76:79]
  v_mfma_f32_16x16x32_bf16 v[48:51], v[164:167], v[116:119], v[48:51]
  v_mfma_f32_16x16x32_bf16 v[20:23], v[164:167], v[112:115], v[20:23]
  s_add_u32 m0, s27, 63552
  s_nop 0
  buffer_load_dwordx4 v207, s[12:15], s24 offen lds
  s_add_u32 s24, s24, s91
  v_mfma_f32_16x16x32_bf16 v[24:27], v[168:171], v[112:115], v[24:27]
  v_mfma_f32_16x16x32_bf16 v[52:55], v[168:171], v[116:119], v[52:55]
  v_mfma_f32_16x16x32_bf16 v[80:83], v[168:171], v[120:123], v[80:83]
  v_mfma_f32_16x16x32_bf16 v[108:111], v[168:171], v[124:127], v[108:111]
  s_waitcnt vmcnt(8) lgkmcnt(0)
  s_barrier
  v_mfma_f32_16x16x32_bf16 v[0:3], v[172:175], v[128:131], v[0:3]
  ds_read_b128 v[112:115], v200 offset:0
  v_mfma_f32_16x16x32_bf16 v[28:31], v[172:175], v[132:135], v[28:31]
  ds_read_b128 v[116:119], v200 offset:1024
  v_mfma_f32_16x16x32_bf16 v[56:59], v[172:175], v[136:139], v[56:59]
  s_add_u32 m0, s25, 95328
  s_nop 0
  buffer_load_dwordx4 v206, s[4:7], s23 offen lds
  ds_read_b128 v[120:123], v200 offset:2048
  v_mfma_f32_16x16x32_bf16 v[84:87], v[172:175], v[140:143], v[84:87]
  ds_read_b128 v[124:127], v200 offset:3072
  v_mfma_f32_16x16x32_bf16 v[88:91], v[176:179], v[140:143], v[88:91]
  ds_read_b64_tr_b16 v[144:145], v202 offset:16384
  v_mfma_f32_16x16x32_bf16 v[60:63], v[176:179], v[136:139], v[60:63]
  ds_read_b64_tr_b16 v[146:147], v202 offset:18176
  v_mfma_f32_16x16x32_bf16 v[32:35], v[176:179], v[132:135], v[32:35]
  ds_read_b64_tr_b16 v[148:149], v202 offset:23568
  v_mfma_f32_16x16x32_bf16 v[4:7], v[176:179], v[128:131], v[4:7]
  ds_read_b64_tr_b16 v[150:151], v202 offset:25360
  v_mfma_f32_16x16x32_bf16 v[8:11], v[180:183], v[128:131], v[8:11]
  ds_read_b64_tr_b16 v[152:153], v202 offset:16416
  v_mfma_f32_16x16x32_bf16 v[36:39], v[180:183], v[132:135], v[36:39]
  buffer_load_dwordx4 v206, s[4:7], s23 offen offset:1024 lds
  s_add_u32 s23, s23, 16384
  ds_read_b64_tr_b16 v[154:155], v202 offset:18208
  v_mfma_f32_16x16x32_bf16 v[64:67], v[180:183], v[136:139], v[64:67]
  ds_read_b64_tr_b16 v[156:157], v202 offset:23600
  v_mfma_f32_16x16x32_bf16 v[92:95], v[180:183], v[140:143], v[92:95]
  ds_read_b64_tr_b16 v[158:159], v202 offset:25392
  v_mfma_f32_16x16x32_bf16 v[96:99], v[184:187], v[140:143], v[96:99]
  ds_read_b64_tr_b16 v[160:161], v202 offset:16448
  v_mfma_f32_16x16x32_bf16 v[68:71], v[184:187], v[136:139], v[68:71]
  ds_read_b64_tr_b16 v[162:163], v202 offset:18240
  v_mfma_f32_16x16x32_bf16 v[40:43], v[184:187], v[132:135], v[40:43]
  ds_read_b64_tr_b16 v[164:165], v202 offset:23632
  v_mfma_f32_16x16x32_bf16 v[12:15], v[184:187], v[128:131], v[12:15]
  ds_read_b64_tr_b16 v[166:167], v202 offset:25424
  v_mfma_f32_16x16x32_bf16 v[16:19], v[188:191], v[128:131], v[16:19]
  s_add_u32 m0, s26, 95328
  s_nop 0
  buffer_load_dwordx4 v207, s[8:11], s24 offen lds
  ds_read_b64_tr_b16 v[168:169], v204 offset:16480
  v_mfma_f32_16x16x32_bf16 v[44:47], v[188:191], v[132:135], v[44:47]
  ds_read_b64_tr_b16 v[170:171], v204 offset:18272
  v_mfma_f32_16x16x32_bf16 v[72:75], v[188:191], v[136:139], v[72:75]
  v_mfma_f32_16x16x32_bf16 v[100:103], v[188:191], v[140:143], v[100:103]
  v_mfma_f32_16x16x32_bf16 v[104:107], v[192:195], v[140:143], v[104:107]
  v_mfma_f32_16x16x32_bf16 v[76:79], v[192:195], v[136:139], v[76:79]
  v_mfma_f32_16x16x32_bf16 v[48:51], v[192:195], v[132:135], v[48:51]
  v_mfma_f32_16x16x32_bf16 v[20:23], v[192:195], v[128:131], v[20:23]
  s_add_u32 m0, s27, 95328
  s_nop 0
  buffer_load_dwordx4 v207, s[12:15], s24 offen lds
  s_add_u32 s24, s24, s91
  v_mfma_f32_16x16x32_bf16 v[24:27], v[196:199], v[128:131], v[24:27]
  v_mfma_f32_16x16x32_bf16 v[52:55], v[196:199], v[132:135], v[52:55]
  v_mfma_f32_16x16x32_bf16 v[80:83], v[196:199], v[136:139], v[80:83]
  v_mfma_f32_16x16x32_bf16 v[108:111], v[196:199], v[140:143], v[108:111]
  s_waitcnt vmcnt(8) lgkmcnt(0)
  s_barrier
  v_mfma_f32_16x16x32_bf16 v[0:3], v[144:147], v[112:115], v[0:3]
  ds_read_b128 v[128:131], v200 offset:31776
  v_mfma_f32_16x16x32_bf16 v[28:31], v[144:147], v[116:119], v[28:31]
  ds_read_b128 v[132:135], v200 offset:32800
  v_mfma_f32_16x16x32_bf16 v[56:59], v[144:147], v[120:123], v[56:59]
  s_add_u32 m0, s25, 0
  s_nop 0
  buffer_load_dwordx4 v206, s[4:7], s23 offen lds
  ds_read_b128 v[136:139], v200 offset:33824
  v_mfma_f32_16x16x32_bf16 v[84:87], v[144:147], v[124:127], v[84:87]
  ds_read_b128 v[140:143], v200 offset:34848
  v_mfma_f32_16x16x32_bf16 v[88:91], v[148:151], v[124:127], v[88:91]
  ds_read_b64_tr_b16 v[172:173], v202 offset:48160
  v_mfma_f32_16x16x32_bf16 v[60:63], v[148:151], v[120:123], v[60:63]
  ds_read_b64_tr_b16 v[174:175], v202 offset:49952
  v_mfma_f32_16x16x32_bf16 v[32:35], v[148:151], v[116:119], v[32:35]
  ds_read_b64_tr_b16 v[176:177], v202 offset:55344
  v_mfma_f32_16x16x32_bf16 v[4:7], v[148:151], v[112:115], v[4:7]
  ds_read_b64_tr_b16 v[178:179], v202 offset:57136
  v_mfma_f32_16x16x32_bf16 v[8:11], v[152:155], v[112:115], v[8:11]
  ds_read_b64_tr_b16 v[180:181], v202 offset:48192
  v_mfma_f32_16x16x32_bf16 v[36:39], v[152:155], v[116:119], v[36:39]
  buffer_load_dwordx4 v206, s[4:7], s23 offen offset:1024 lds
  s_add_u32 s23, s23, 16384
  ds_read_b64_tr_b16 v[182:183], v202 offset:49984
  v_mfma_f32_16x16x32_bf16 v[64:67], v[152:155], v[120:123], v[64:67]
  ds_read_b64_tr_b16 v[184:185], v202 offset:55376
  v_mfma_f32_16x16x32_bf16 v[92:95], v[152:155], v[124:127], v[92:95]
  ds_read_b64_tr_b16 v[186:187], v202 offset:57168
  v_mfma_f32_16x16x32_bf16 v[96:99], v[156:159], v[124:127], v[96:99]
  ds_read_b64_tr_b16 v[188:189], v202 offset:48224
  v_mfma_f32_16x16x32_bf16 v[68:71], v[156:159], v[120:123], v[68:71]
  ds_read_b64_tr_b16 v[190:191], v202 offset:50016
  v_mfma_f32_16x16x32_bf16 v[40:43], v[156:159], v[116:119], v[40:43]
  ds_read_b64_tr_b16 v[192:193], v202 offset:55408
  v_mfma_f32_16x16x32_bf16 v[12:15], v[156:159], v[112:115], v[12:15]
  ds_read_b64_tr_b16 v[194:195], v202 offset:57200
  v_mfma_f32_16x16x32_bf16 v[16:19], v[160:163], v[112:115], v[16:19]
  s_add_u32 m0, s26, 0
  s_nop 0
  buffer_load_dwordx4 v207, s[8:11], s24 offen lds
  ds_read_b64_tr_b16 v[196:197], v204 offset:48256
  v_mfma_f32_16x16x32_bf16 v[44:47], v[160:163], v[116:119], v[44:47]
  ds_read_b64_tr_b16 v[198:199], v204 offset:50048
  v_mfma_f32_16x16x32_bf16 v[72:75], v[160:163], v[120:123], v[72:75]
  v_mfma_f32_16x16x32_bf16 v[100:103], v[160:163], v[124:127], v[100:103]
  v_mfma_f32_16x16x32_bf16 v[104:107], v[164:167], v[124:127], v[104:107]
  v_mfma_f32_16x16x32_bf16 v[76:79], v[164:167], v[120:123], v[76:79]
  v_mfma_f32_16x16x32_bf16 v[48:51], v[164:167], v[116:119], v[48:51]
  v_mfma_f32_16x16x32_bf16 v[20:23], v[164:167], v[112:115], v[20:23]
  s_add_u32 m0, s27, 0
  s_nop 0
  buffer_load_dwordx4 v207, s[12:15], s24 offen lds
  s_add_u32 s24, s24, s91
  v_mfma_f32_16x16x32_bf16 v[24:27], v[168:171], v[112:115], v[24:27]
  v_mfma_f32_16x16x32_bf16 v[52:55], v[168:171], v[116:119], v[52:55]
  v_mfma_f32_16x16x32_bf16 v[80:83], v[168:171], v[120:123], v[80:83]
  v_mfma_f32_16x16x32_bf16 v[108:111], v[168:171], v[124:127], v[108:111]
  s_sub_u32 s28, s28, 1
  s_cmp_lg_u32 s28, 0
  s_cbranch_scc1 mlp_loop
  s_mov_b32 s8, s44
  s_mov_b32 s9, s45
  s_mov_b32 s10, 0x700000
  s_mov_b32 s11, 0x20000
  s_lshl_b32 s23, s2, 15
  s_add_u32 s24, s23, 16384
  s_and_b32 s86, s2, 7
  s_lshr_b32 s87, s2, 3
  s_and_b32 s82, s86, 1
  s_lshr_b32 s83, s86, 1
  s_lshl_b32 s83, s83, 2
  s_and_b32 s88, s87, 3
  s_add_u32 s83, s83, s88
  s_lshr_b32 s84, s87, 2
  v_lshrrev_b32 v252, 4, v208
  s_and_b32 s86, s20, 1
  s_lshl_b32 s86, s86, 2
  v_add_u32 v253, s86, v252
  v_lshlrev_b32 v253, 1, v253
  v_and_b32 v254, 15, v208
  v_xor_b32 v253, v253, v254
  v_lshlrev_b32 v253, 4, v253
  v_lshl_add_u32 v255, v252, 11, v253
  s_lshl_b32 s86, s84, 8
  v_add_u32 v255, s86, v255
  s_lshr_b32 s86, s20, 2
  s_and_b32 s87, s20, 3
  s_mul_i32 s88, s82, 1792
  s_mul_i32 s76, s86, 56
  s_lshl_b32 s81, s87, 2
  s_add_u32 s76, s76, s81
  s_add_u32 s76, s76, s88
  s_lshl_b32 s76, s76, 11
  s_mul_i32 s80, s86, 112
  s_lshr_b32 s81, s87, 1
  s_mul_i32 s81, s81, 56
  s_add_u32 s80, s80, s81
  s_and_b32 s81, s87, 1
  s_lshl_b32 s81, s81, 3
  s_add_u32 s80, s80, s81
  s_add_u32 s80, s80, s88
  s_add_u32 s80, s80, 32
  s_lshl_b32 s80, s80, 11
  s_mul_i32 s81, s86, 224
  s_mul_i32 s87, s87, 56
  s_add_u32 s81, s81, s87
  s_add_u32 s81, s81, s88
  s_add_u32 s81, s81, 48
  s_lshl_b32 s81, s81, 11
  s_mov_b32 s77, 31744
  s_mov_b32 s78, 229376
  s_mov_b32 s72, s44
  s_mov_b32 s73, s45
  s_mov_b32 s74, 0x700000
  s_mov_b32 s75, 0x20000
  s_waitcnt vmcnt(8) lgkmcnt(0)
  s_barrier
  v_mfma_f32_16x16x32_bf16 v[0:3], v[172:175], v[128:131], v[0:3]
  ds_read_b128 v[112:115], v201 offset:0
  v_mfma_f32_16x16x32_bf16 v[28:31], v[172:175], v[132:135], v[28:31]
  ds_read_b128 v[116:119], v201 offset:1024
  v_mfma_f32_16x16x32_bf16 v[56:59], v[172:175], v[136:139], v[56:59]
  ds_read_b128 v[120:123], v201 offset:2048
  v_mfma_f32_16x16x32_bf16 v[84:87], v[172:175], v[140:143], v[84:87]
  ds_read_b128 v[124:127], v201 offset:3072
  v_mfma_f32_16x16x32_bf16 v[88:91], v[176:179], v[140:143], v[88:91]
  ds_read_b64_tr_b16 v[144:145], v203 offset:16384
  v_mfma_f32_16x16x32_bf16 v[60:63], v[176:179], v[136:139], v[60:63]
  ds_read_b64_tr_b16 v[146:147], v203 offset:18176
  v_mfma_f32_16x16x32_bf16 v[32:35], v[176:179], v[132:135], v[32:35]
  ds_read_b64_tr_b16 v[148:149], v203 offset:23568
  v_mfma_f32_16x16x32_bf16 v[4:7], v[176:179], v[128:131], v[4:7]
  ds_read_b64_tr_b16 v[150:151], v203 offset:25360
  v_mfma_f32_16x16x32_bf16 v[8:11], v[180:183], v[128:131], v[8:11]
  ds_read_b64_tr_b16 v[152:153], v203 offset:16416
  v_mfma_f32_16x16x32_bf16 v[36:39], v[180:183], v[132:135], v[36:39]
  ds_read_b64_tr_b16 v[154:155], v203 offset:18208
  v_mfma_f32_16x16x32_bf16 v[64:67], v[180:183], v[136:139], v[64:67]
  ds_read_b64_tr_b16 v[156:157], v203 offset:23600
  v_mfma_f32_16x16x32_bf16 v[92:95], v[180:183], v[140:143], v[92:95]
  ds_read_b64_tr_b16 v[158:159], v203 offset:25392
  v_mfma_f32_16x16x32_bf16 v[96:99], v[184:187], v[140:143], v[96:99]
  ds_read_b64_tr_b16 v[160:161], v203 offset:16448
  v_mfma_f32_16x16x32_bf16 v[68:71], v[184:187], v[136:139], v[68:71]
  ds_read_b64_tr_b16 v[162:163], v203 offset:18240
  v_mfma_f32_16x16x32_bf16 v[40:43], v[184:187], v[132:135], v[40:43]
  ds_read_b64_tr_b16 v[164:165], v203 offset:23632
  v_mfma_f32_16x16x32_bf16 v[12:15], v[184:187], v[128:131], v[12:15]
  ds_read_b64_tr_b16 v[166:167], v203 offset:25424
  v_mfma_f32_16x16x32_bf16 v[16:19], v[188:191], v[128:131], v[16:19]
  ds_read_b64_tr_b16 v[168:169], v205 offset:16480
  v_mfma_f32_16x16x32_bf16 v[44:47], v[188:191], v[132:135], v[44:47]
  ds_read_b64_tr_b16 v[170:171], v205 offset:18272
  v_mfma_f32_16x16x32_bf16 v[72:75], v[188:191], v[136:139], v[72:75]
  v_mfma_f32_16x16x32_bf16 v[100:103], v[188:191], v[140:143], v[100:103]
  v_mfma_f32_16x16x32_bf16 v[104:107], v[192:195], v[140:143], v[104:107]
  v_mfma_f32_16x16x32_bf16 v[76:79], v[192:195], v[136:139], v[76:79]
  v_mfma_f32_16x16x32_bf16 v[48:51], v[192:195], v[132:135], v[48:51]
  v_mfma_f32_16x16x32_bf16 v[20:23], v[192:195], v[128:131], v[20:23]
  v_mfma_f32_16x16x32_bf16 v[24:27], v[196:199], v[128:131], v[24:27]
  v_mfma_f32_16x16x32_bf16 v[52:55], v[196:199], v[132:135], v[52:55]
  v_mfma_f32_16x16x32_bf16 v[80:83], v[196:199], v[136:139], v[80:83]
  v_mfma_f32_16x16x32_bf16 v[108:111], v[196:199], v[140:143], v[108:111]
  s_waitcnt vmcnt(0) lgkmcnt(0)
  s_barrier
  v_mfma_f32_16x16x32_bf16 v[0:3], v[144:147], v[112:115], v[0:3]
  ds_read_b128 v[128:131], v201 offset:31776
  v_mfma_f32_16x16x32_bf16 v[28:31], v[144:147], v[116:119], v[28:31]
  s_add_u32 m0, s25, 16384
  s_add_u32 s79, s76, s77
  buffer_load_dwordx4 v255, s[72:75], s76 offen lds
  ds_read_b128 v[132:135], v201 offset:32800
  v_mfma_f32_16x16x32_bf16 v[56:59], v[144:147], v[120:123], v[56:59]
  ds_read_b128 v[136:139], v201 offset:33824
  v_mfma_f32_16x16x32_bf16 v[84:87], v[144:147], v[124:127], v[84:87]
  ds_read_b128 v[140:143], v201 offset:34848
  v_mfma_f32_16x16x32_bf16 v[88:91], v[148:151], v[124:127], v[88:91]
  buffer_load_dwordx4 v255, s[72:75], s79 offen offset:1024 lds
  s_add_u32 s76, s76, s78
  ds_read_b64_tr_b16 v[172:173], v203 offset:48160
  v_mfma_f32_16x16x32_bf16 v[60:63], v[148:151], v[120:123], v[60:63]
  ds_read_b64_tr_b16 v[174:175], v203 offset:49952
  v_mfma_f32_16x16x32_bf16 v[32:35], v[148:151], v[116:119], v[32:35]
  ds_read_b64_tr_b16 v[176:177], v203 offset:55344
  v_mfma_f32_16x16x32_bf16 v[4:7], v[148:151], v[112:115], v[4:7]
  s_add_u32 m0, s25, 49152
  s_add_u32 s79, s76, s77
  buffer_load_dwordx4 v255, s[72:75], s76 offen lds
  ds_read_b64_tr_b16 v[178:179], v203 offset:57136
  v_mfma_f32_16x16x32_bf16 v[8:11], v[152:155], v[112:115], v[8:11]
  ds_read_b64_tr_b16 v[180:181], v203 offset:48192
  v_mfma_f32_16x16x32_bf16 v[36:39], v[152:155], v[116:119], v[36:39]
  ds_read_b64_tr_b16 v[182:183], v203 offset:49984
  v_mfma_f32_16x16x32_bf16 v[64:67], v[152:155], v[120:123], v[64:67]
  buffer_load_dwordx4 v255, s[72:75], s79 offen offset:1024 lds
  s_add_u32 s76, s76, s78
  ds_read_b64_tr_b16 v[184:185], v203 offset:55376
  v_mfma_f32_16x16x32_bf16 v[92:95], v[152:155], v[124:127], v[92:95]
  ds_read_b64_tr_b16 v[186:187], v203 offset:57168
  v_mfma_f32_16x16x32_bf16 v[96:99], v[156:159], v[124:127], v[96:99]
  ds_read_b64_tr_b16 v[188:189], v203 offset:48224
  v_mfma_f32_16x16x32_bf16 v[68:71], v[156:159], v[120:123], v[68:71]
  ds_read_b64_tr_b16 v[190:191], v203 offset:50016
  v_mfma_f32_16x16x32_bf16 v[40:43], v[156:159], v[116:119], v[40:43]
  ds_read_b64_tr_b16 v[192:193], v203 offset:55408
  v_mfma_f32_16x16x32_bf16 v[12:15], v[156:159], v[112:115], v[12:15]
  ds_read_b64_tr_b16 v[194:195], v203 offset:57200
  v_mfma_f32_16x16x32_bf16 v[16:19], v[160:163], v[112:115], v[16:19]
  ds_read_b64_tr_b16 v[196:197], v205 offset:48256
  v_mfma_f32_16x16x32_bf16 v[44:47], v[160:163], v[116:119], v[44:47]
  ds_read_b64_tr_b16 v[198:199], v205 offset:50048
  v_mfma_f32_16x16x32_bf16 v[72:75], v[160:163], v[120:123], v[72:75]
  v_mfma_f32_16x16x32_bf16 v[100:103], v[160:163], v[124:127], v[100:103]
  v_mfma_f32_16x16x32_bf16 v[104:107], v[164:167], v[124:127], v[104:107]
  v_mfma_f32_16x16x32_bf16 v[76:79], v[164:167], v[120:123], v[76:79]
  v_mfma_f32_16x16x32_bf16 v[48:51], v[164:167], v[116:119], v[48:51]
  v_mfma_f32_16x16x32_bf16 v[20:23], v[164:167], v[112:115], v[20:23]
  v_mfma_f32_16x16x32_bf16 v[24:27], v[168:171], v[112:115], v[24:27]
  v_mfma_f32_16x16x32_bf16 v[52:55], v[168:171], v[116:119], v[52:55]
  v_mfma_f32_16x16x32_bf16 v[80:83], v[168:171], v[120:123], v[80:83]
  v_mfma_f32_16x16x32_bf16 v[108:111], v[168:171], v[124:127], v[108:111]
  s_waitcnt vmcnt(63) lgkmcnt(0)
  v_mfma_f32_16x16x32_bf16 v[0:3], v[172:175], v[128:131], v[0:3]
  v_mfma_f32_16x16x32_bf16 v[28:31], v[172:175], v[132:135], v[28:31]
  v_mfma_f32_16x16x32_bf16 v[56:59], v[172:175], v[136:139], v[56:59]
  v_mfma_f32_16x16x32_bf16 v[84:87], v[172:175], v[140:143], v[84:87]
  v_mfma_f32_16x16x32_bf16 v[88:91], v[176:179], v[140:143], v[88:91]
  v_mfma_f32_16x16x32_bf16 v[60:63], v[176:179], v[136:139], v[60:63]
  v_mfma_f32_16x16x32_bf16 v[32:35], v[176:179], v[132:135], v[32:35]
  v_mfma_f32_16x16x32_bf16 v[4:7], v[176:179], v[128:131], v[4:7]
  v_mfma_f32_16x16x32_bf16 v[8:11], v[180:183], v[128:131], v[8:11]
  v_mfma_f32_16x16x32_bf16 v[36:39], v[180:183], v[132:135], v[36:39]
  v_mfma_f32_16x16x32_bf16 v[64:67], v[180:183], v[136:139], v[64:67]
  v_mfma_f32_16x16x32_bf16 v[92:95], v[180:183], v[140:143], v[92:95]
  v_mfma_f32_16x16x32_bf16 v[96:99], v[184:187], v[140:143], v[96:99]
  v_mfma_f32_16x16x32_bf16 v[68:71], v[184:187], v[136:139], v[68:71]
  v_mfma_f32_16x16x32_bf16 v[40:43], v[184:187], v[132:135], v[40:43]
  v_mfma_f32_16x16x32_bf16 v[12:15], v[184:187], v[128:131], v[12:15]
  v_mfma_f32_16x16x32_bf16 v[16:19], v[188:191], v[128:131], v[16:19]
  v_mfma_f32_16x16x32_bf16 v[44:47], v[188:191], v[132:135], v[44:47]
  v_mfma_f32_16x16x32_bf16 v[72:75], v[188:191], v[136:139], v[72:75]
  v_mfma_f32_16x16x32_bf16 v[100:103], v[188:191], v[140:143], v[100:103]
  v_mfma_f32_16x16x32_bf16 v[104:107], v[192:195], v[140:143], v[104:107]
  v_mfma_f32_16x16x32_bf16 v[76:79], v[192:195], v[136:139], v[76:79]
  v_mfma_f32_16x16x32_bf16 v[48:51], v[192:195], v[132:135], v[48:51]
  v_mfma_f32_16x16x32_bf16 v[20:23], v[192:195], v[128:131], v[20:23]
  v_mfma_f32_16x16x32_bf16 v[24:27], v[196:199], v[128:131], v[24:27]
  v_mfma_f32_16x16x32_bf16 v[52:55], v[196:199], v[132:135], v[52:55]
  v_mfma_f32_16x16x32_bf16 v[80:83], v[196:199], v[136:139], v[80:83]
  v_mfma_f32_16x16x32_bf16 v[108:111], v[196:199], v[140:143], v[108:111]
  s_mov_b32 s38, 0xbdd2d3e8
  s_mov_b32 s39, 0xbdd2d3e8
  v_mov_b32 v216, 0xc0135761
  v_mov_b32 v217, 0xc0135761
  v_mov_b32 v218, 1.0
  v_mov_b32 v219, 1.0
  s_and_b32 s29, s20, 3
  s_lshl_b32 s29, s29, 2
  s_lshl_b32 s30, s21, 4
  s_add_u32 s29, s29, s30
  s_mul_i32 s29, s29, 114688
  s_lshr_b32 s30, s20, 2
  s_lshl_b32 s40, s22, 1
  s_add_u32 s40, s40, s30
  s_and_b32 s40, s40, 31
  s_lshr_b32 s43, s22, 4
  s_mul_i32 s43, s43, 56
  s_add_u32 s40, s40, s43
  s_lshl_b32 s40, s40, 10
  s_add_u32 s40, s40, s29
  s_and_b32 s41, s22, 15
  s_add_u32 s41, s41, s43
  s_add_u32 s41, s41, 32
  s_lshl_b32 s41, s41, 10
  s_add_u32 s41, s41, s29
  s_lshr_b32 s42, s22, 1
  s_and_b32 s42, s42, 7
  s_add_u32 s42, s42, s43
  s_add_u32 s42, s42, 48
  s_lshl_b32 s42, s42, 10
  s_add_u32 s42, s42, s29
  v_lshlrev_b32 v213, 4, v208
  v_and_b32 v210, 15, v208
  v_lshlrev_b32 v210, 4, v210
  v_bfe_u32 v209, v208, 4, 1
  v_mul_u32_u24 v211, 114688, v209
  v_lshrrev_b32 v212, 5, v208
  v_lshl_add_u32 v214, v212, 8, v211
  v_add_u32 v214, v214, v210
  s_lshl_b32 s31, s30, 9
  v_add_u32 v214, s31, v214
  v_lshl_add_u32 v209, v209, 1, v212
  v_mul_u32_u24 v215, 114688, v209
  v_add_u32 v215, v215, v210
  s_and_b32 s31, s22, 1
  s_lshl_b32 s31, s31, 1
  s_add_u32 s31, s31, s30
  s_lshl_b32 s31, s31, 8
  v_add_u32 v215, s31, v215
  v_pk_mul_f32 v[220:221], v[0:1], v[0:1]
  v_pk_mul_f32 v[222:223], v[2:3], v[2:3]
  v_pk_fma_f32 v[220:221], v[220:221], s[38:39], v[216:217]
  v_pk_fma_f32 v[222:223], v[222:223], s[38:39], v[216:217]
  v_pk_mul_f32 v[220:221], v[220:221], v[0:1]
  v_pk_mul_f32 v[222:223], v[222:223], v[2:3]
  v_exp_f32 v220, v220
  v_exp_f32 v221, v221
  v_exp_f32 v222, v222
  v_exp_f32 v223, v223
  v_pk_mul_f32 v[224:225], v[0:1], v[4:5]
  v_pk_mul_f32 v[226:227], v[2:3], v[6:7]
  v_pk_add_f32 v[220:221], v[220:221], v[218:219]
  v_pk_add_f32 v[222:223], v[222:223], v[218:219]
  v_rcp_f32 v220, v220
  v_rcp_f32 v221, v221
  v_rcp_f32 v222, v222
  v_rcp_f32 v223, v223
  v_pk_mul_f32 v[224:225], v[224:225], v[220:221]
  v_pk_mul_f32 v[226:227], v[226:227], v[222:223]
  v_cvt_pk_bf16_f32 v228, v224, v225
  v_cvt_pk_bf16_f32 v229, v226, v227
  v_pk_mul_f32 v[220:221], v[8:9], v[8:9]
  v_pk_mul_f32 v[222:223], v[10:11], v[10:11]
  v_pk_fma_f32 v[220:221], v[220:221], s[38:39], v[216:217]
  v_pk_fma_f32 v[222:223], v[222:223], s[38:39], v[216:217]
  v_pk_mul_f32 v[220:221], v[220:221], v[8:9]
  v_pk_mul_f32 v[222:223], v[222:223], v[10:11]
  v_exp_f32 v220, v220
  v_exp_f32 v221, v221
  v_exp_f32 v222, v222
  v_exp_f32 v223, v223
  v_pk_mul_f32 v[224:225], v[8:9], v[12:13]
  v_pk_mul_f32 v[226:227], v[10:11], v[14:15]
  v_pk_add_f32 v[220:221], v[220:221], v[218:219]
  v_pk_add_f32 v[222:223], v[222:223], v[218:219]
  v_rcp_f32 v220, v220
  v_rcp_f32 v221, v221
  v_rcp_f32 v222, v222
  v_rcp_f32 v223, v223
  v_pk_mul_f32 v[224:225], v[224:225], v[220:221]
  v_pk_mul_f32 v[226:227], v[226:227], v[222:223]
  v_cvt_pk_bf16_f32 v230, v224, v225
  v_cvt_pk_bf16_f32 v231, v226, v227
  buffer_store_dwordx4 v[228:231], v213, s[16:19], s40 offen sc1
  v_pk_mul_f32 v[220:221], v[16:17], v[16:17]
  v_pk_mul_f32 v[222:223], v[18:19], v[18:19]
  v_pk_fma_f32 v[220:221], v[220:221], s[38:39], v[216:217]
  v_pk_fma_f32 v[222:223], v[222:223], s[38:39], v[216:217]
  v_pk_mul_f32 v[220:221], v[220:221], v[16:17]
  v_pk_mul_f32 v[222:223], v[222:223], v[18:19]
  v_exp_f32 v220, v220
  v_exp_f32 v221, v221
  v_exp_f32 v222, v222
  v_exp_f32 v223, v223
  v_pk_mul_f32 v[224:225], v[16:17], v[20:21]
  v_pk_mul_f32 v[226:227], v[18:19], v[22:23]
  v_pk_add_f32 v[220:221], v[220:221], v[218:219]
  v_pk_add_f32 v[222:223], v[222:223], v[218:219]
  v_rcp_f32 v220, v220
  v_rcp_f32 v221, v221
  v_rcp_f32 v222, v222
  v_rcp_f32 v223, v223
  v_pk_mul_f32 v[224:225], v[224:225], v[220:221]
  v_pk_mul_f32 v[226:227], v[226:227], v[222:223]
  v_cvt_pk_bf16_f32 v236, v224, v225
  v_cvt_pk_bf16_f32 v237, v226, v227
  s_add_u32 s40, s40, 114688
  v_pk_mul_f32 v[220:221], v[28:29], v[28:29]
  v_pk_mul_f32 v[222:223], v[30:31], v[30:31]
  v_pk_fma_f32 v[220:221], v[220:221], s[38:39], v[216:217]
  v_pk_fma_f32 v[222:223], v[222:223], s[38:39], v[216:217]
  v_pk_mul_f32 v[220:221], v[220:221], v[28:29]
  v_pk_mul_f32 v[222:223], v[222:223], v[30:31]
  v_exp_f32 v220, v220
  v_exp_f32 v221, v221
  v_exp_f32 v222, v222
  v_exp_f32 v223, v223
  v_pk_mul_f32 v[224:225], v[28:29], v[32:33]
  v_pk_mul_f32 v[226:227], v[30:31], v[34:35]
  v_pk_add_f32 v[220:221], v[220:221], v[218:219]
  v_pk_add_f32 v[222:223], v[222:223], v[218:219]
  v_rcp_f32 v220, v220
  v_rcp_f32 v221, v221
  v_rcp_f32 v222, v222
  v_rcp_f32 v223, v223
  v_pk_mul_f32 v[224:225], v[224:225], v[220:221]
  v_pk_mul_f32 v[226:227], v[226:227], v[222:223]
  v_cvt_pk_bf16_f32 v232, v224, v225
  v_cvt_pk_bf16_f32 v233, v226, v227
  v_pk_mul_f32 v[220:221], v[36:37], v[36:37]
  v_pk_mul_f32 v[222:223], v[38:39], v[38:39]
  v_pk_fma_f32 v[220:221], v[220:221], s[38:39], v[216:217]
  v_pk_fma_f32 v[222:223], v[222:223], s[38:39], v[216:217]
  v_pk_mul_f32 v[220:221], v[220:221], v[36:37]
  v_pk_mul_f32 v[222:223], v[222:223], v[38:39]
  v_exp_f32 v220, v220
  v_exp_f32 v221, v221
  v_exp_f32 v222, v222
  v_exp_f32 v223, v223
  v_pk_mul_f32 v[224:225], v[36:37], v[40:41]
  v_pk_mul_f32 v[226:227], v[38:39], v[42:43]
  v_pk_add_f32 v[220:221], v[220:221], v[218:219]
  v_pk_add_f32 v[222:223], v[222:223], v[218:219]
  v_rcp_f32 v220, v220
  v_rcp_f32 v221, v221
  v_rcp_f32 v222, v222
  v_rcp_f32 v223, v223
  v_pk_mul_f32 v[224:225], v[224:225], v[220:221]
  v_pk_mul_f32 v[226:227], v[226:227], v[222:223]
  v_cvt_pk_bf16_f32 v234, v224, v225
  v_cvt_pk_bf16_f32 v235, v226, v227
  buffer_store_dwordx4 v[232:235], v213, s[16:19], s40 offen sc1
  v_pk_mul_f32 v[220:221], v[44:45], v[44:45]
  v_pk_mul_f32 v[222:223], v[46:47], v[46:47]
  v_pk_fma_f32 v[220:221], v[220:221], s[38:39], v[216:217]
  v_pk_fma_f32 v[222:223], v[222:223], s[38:39], v[216:217]
  v_pk_mul_f32 v[220:221], v[220:221], v[44:45]
  v_pk_mul_f32 v[222:223], v[222:223], v[46:47]
  v_exp_f32 v220, v220
  v_exp_f32 v221, v221
  v_exp_f32 v222, v222
  v_exp_f32 v223, v223
  v_pk_mul_f32 v[224:225], v[44:45], v[48:49]
  v_pk_mul_f32 v[226:227], v[46:47], v[50:51]
  v_pk_add_f32 v[220:221], v[220:221], v[218:219]
  v_pk_add_f32 v[222:223], v[222:223], v[218:219]
  v_rcp_f32 v220, v220
  v_rcp_f32 v221, v221
  v_rcp_f32 v222, v222
  v_rcp_f32 v223, v223
  v_pk_mul_f32 v[224:225], v[224:225], v[220:221]
  v_pk_mul_f32 v[226:227], v[226:227], v[222:223]
  v_cvt_pk_bf16_f32 v238, v224, v225
  v_cvt_pk_bf16_f32 v239, v226, v227
  s_nop 0
  v_permlane16_swap_b32 v236, v238
  v_permlane16_swap_b32 v237, v239
  buffer_store_dwordx4 v[236:239], v214, s[16:19], s41 offen sc1
  s_add_u32 s41, s41, 229376
  v_permlane32_swap_b32 v24, v52
  v_permlane32_swap_b32 v25, v53
  v_permlane32_swap_b32 v26, v54
  v_permlane32_swap_b32 v27, v55
  v_pk_mul_f32 v[220:221], v[24:25], v[24:25]
  v_pk_mul_f32 v[222:223], v[26:27], v[26:27]
  v_pk_fma_f32 v[220:221], v[220:221], s[38:39], v[216:217]
  v_pk_fma_f32 v[222:223], v[222:223], s[38:39], v[216:217]
  v_pk_mul_f32 v[220:221], v[220:221], v[24:25]
  v_pk_mul_f32 v[222:223], v[222:223], v[26:27]
  v_exp_f32 v220, v220
  v_exp_f32 v221, v221
  v_exp_f32 v222, v222
  v_exp_f32 v223, v223
  v_pk_mul_f32 v[224:225], v[24:25], v[52:53]
  v_pk_mul_f32 v[226:227], v[26:27], v[54:55]
  v_pk_add_f32 v[220:221], v[220:221], v[218:219]
  v_pk_add_f32 v[222:223], v[222:223], v[218:219]
  v_rcp_f32 v220, v220
  v_rcp_f32 v221, v221
  v_rcp_f32 v222, v222
  v_rcp_f32 v223, v223
  v_pk_mul_f32 v[224:225], v[224:225], v[220:221]
  v_pk_mul_f32 v[226:227], v[226:227], v[222:223]
  v_cvt_pk_bf16_f32 v244, v224, v225
  v_cvt_pk_bf16_f32 v245, v226, v227
  s_add_u32 s40, s40, 114688
  v_pk_mul_f32 v[220:221], v[56:57], v[56:57]
  v_pk_mul_f32 v[222:223], v[58:59], v[58:59]
  v_pk_fma_f32 v[220:221], v[220:221], s[38:39], v[216:217]
  v_pk_fma_f32 v[222:223], v[222:223], s[38:39], v[216:217]
  v_pk_mul_f32 v[220:221], v[220:221], v[56:57]
  v_pk_mul_f32 v[222:223], v[222:223], v[58:59]
  v_exp_f32 v220, v220
  v_exp_f32 v221, v221
  v_exp_f32 v222, v222
  v_exp_f32 v223, v223
  v_pk_mul_f32 v[224:225], v[56:57], v[60:61]
  v_pk_mul_f32 v[226:227], v[58:59], v[62:63]
  v_pk_add_f32 v[220:221], v[220:221], v[218:219]
  v_pk_add_f32 v[222:223], v[222:223], v[218:219]
  v_rcp_f32 v220, v220
  v_rcp_f32 v221, v221
  v_rcp_f32 v222, v222
  v_rcp_f32 v223, v223
  v_pk_mul_f32 v[224:225], v[224:225], v[220:221]
  v_pk_mul_f32 v[226:227], v[226:227], v[222:223]
  v_cvt_pk_bf16_f32 v228, v224, v225
  v_cvt_pk_bf16_f32 v229, v226, v227
  v_pk_mul_f32 v[220:221], v[64:65], v[64:65]
  v_pk_mul_f32 v[222:223], v[66:67], v[66:67]
  v_pk_fma_f32 v[220:221], v[220:221], s[38:39], v[216:217]
  v_pk_fma_f32 v[222:223], v[222:223], s[38:39], v[216:217]
  v_pk_mul_f32 v[220:221], v[220:221], v[64:65]
  v_pk_mul_f32 v[222:223], v[222:223], v[66:67]
  v_exp_f32 v220, v220
  v_exp_f32 v221, v221
  v_exp_f32 v222, v222
  v_exp_f32 v223, v223
  v_pk_mul_f32 v[224:225], v[64:65], v[68:69]
  v_pk_mul_f32 v[226:227], v[66:67], v[70:71]
  v_pk_add_f32 v[220:221], v[220:221], v[218:219]
  v_pk_add_f32 v[222:223], v[222:223], v[218:219]
  v_rcp_f32 v220, v220
  v_rcp_f32 v221, v221
  v_rcp_f32 v222, v222
  v_rcp_f32 v223, v223
  v_pk_mul_f32 v[224:225], v[224:225], v[220:221]
  v_pk_mul_f32 v[226:227], v[226:227], v[222:223]
  v_cvt_pk_bf16_f32 v230, v224, v225
  v_cvt_pk_bf16_f32 v231, v226, v227
  buffer_store_dwordx4 v[228:231], v213, s[16:19], s40 offen sc1
  v_pk_mul_f32 v[220:221], v[72:73], v[72:73]
  v_pk_mul_f32 v[222:223], v[74:75], v[74:75]
  v_pk_fma_f32 v[220:221], v[220:221], s[38:39], v[216:217]
  v_pk_fma_f32 v[222:223], v[222:223], s[38:39], v[216:217]
  v_pk_mul_f32 v[220:221], v[220:221], v[72:73]
  v_pk_mul_f32 v[222:223], v[222:223], v[74:75]
  v_exp_f32 v220, v220
  v_exp_f32 v221, v221
  v_exp_f32 v222, v222
  v_exp_f32 v223, v223
  v_pk_mul_f32 v[224:225], v[72:73], v[76:77]
  v_pk_mul_f32 v[226:227], v[74:75], v[78:79]
  v_pk_add_f32 v[220:221], v[220:221], v[218:219]
  v_pk_add_f32 v[222:223], v[222:223], v[218:219]
  v_rcp_f32 v220, v220
  v_rcp_f32 v221, v221
  v_rcp_f32 v222, v222
  v_rcp_f32 v223, v223
  v_pk_mul_f32 v[224:225], v[224:225], v[220:221]
  v_pk_mul_f32 v[226:227], v[226:227], v[222:223]
  v_cvt_pk_bf16_f32 v240, v224, v225
  v_cvt_pk_bf16_f32 v241, v226, v227
  s_add_u32 s40, s40, 114688
  v_pk_mul_f32 v[220:221], v[84:85], v[84:85]
  v_pk_mul_f32 v[222:223], v[86:87], v[86:87]
  v_pk_fma_f32 v[220:221], v[220:221], s[38:39], v[216:217]
  v_pk_fma_f32 v[222:223], v[222:223], s[38:39], v[216:217]
  v_pk_mul_f32 v[220:221], v[220:221], v[84:85]
  v_pk_mul_f32 v[222:223], v[222:223], v[86:87]
  v_exp_f32 v220, v220
  v_exp_f32 v221, v221
  v_exp_f32 v222, v222
  v_exp_f32 v223, v223
  v_pk_mul_f32 v[224:225], v[84:85], v[88:89]
  v_pk_mul_f32 v[226:227], v[86:87], v[90:91]
  v_pk_add_f32 v[220:221], v[220:221], v[218:219]
  v_pk_add_f32 v[222:223], v[222:223], v[218:219]
  v_rcp_f32 v220, v220
  v_rcp_f32 v221, v221
  v_rcp_f32 v222, v222
  v_rcp_f32 v223, v223
  v_pk_mul_f32 v[224:225], v[224:225], v[220:221]
  v_pk_mul_f32 v[226:227], v[226:227], v[222:223]
  v_cvt_pk_bf16_f32 v232, v224, v225
  v_cvt_pk_bf16_f32 v233, v226, v227
  v_pk_mul_f32 v[220:221], v[92:93], v[92:93]
  v_pk_mul_f32 v[222:223], v[94:95], v[94:95]
  v_pk_fma_f32 v[220:221], v[220:221], s[38:39], v[216:217]
  v_pk_fma_f32 v[222:223], v[222:223], s[38:39], v[216:217]
  v_pk_mul_f32 v[220:221], v[220:221], v[92:93]
  v_pk_mul_f32 v[222:223], v[222:223], v[94:95]
  v_exp_f32 v220, v220
  v_exp_f32 v221, v221
  v_exp_f32 v222, v222
  v_exp_f32 v223, v223
  v_pk_mul_f32 v[224:225], v[92:93], v[96:97]
  v_pk_mul_f32 v[226:227], v[94:95], v[98:99]
  v_pk_add_f32 v[220:221], v[220:221], v[218:219]
  v_pk_add_f32 v[222:223], v[222:223], v[218:219]
  v_rcp_f32 v220, v220
  v_rcp_f32 v221, v221
  v_rcp_f32 v222, v222
  v_rcp_f32 v223, v223
  v_pk_mul_f32 v[224:225], v[224:225], v[220:221]
  v_pk_mul_f32 v[226:227], v[226:227], v[222:223]
  v_cvt_pk_bf16_f32 v234, v224, v225
  v_cvt_pk_bf16_f32 v235, v226, v227
  buffer_store_dwordx4 v[232:235], v213, s[16:19], s40 offen sc1
  v_pk_mul_f32 v[220:221], v[100:101], v[100:101]
  v_pk_mul_f32 v[222:223], v[102:103], v[102:103]
  v_pk_fma_f32 v[220:221], v[220:221], s[38:39], v[216:217]
  v_pk_fma_f32 v[222:223], v[222:223], s[38:39], v[216:217]
  v_pk_mul_f32 v[220:221], v[220:221], v[100:101]
  v_pk_mul_f32 v[222:223], v[222:223], v[102:103]
  v_exp_f32 v220, v220
  v_exp_f32 v221, v221
  v_exp_f32 v222, v222
  v_exp_f32 v223, v223
  v_pk_mul_f32 v[224:225], v[100:101], v[104:105]
  v_pk_mul_f32 v[226:227], v[102:103], v[106:107]
  v_pk_add_f32 v[220:221], v[220:221], v[218:219]
  v_pk_add_f32 v[222:223], v[222:223], v[218:219]
  v_rcp_f32 v220, v220
  v_rcp_f32 v221, v221
  v_rcp_f32 v222, v222
  v_rcp_f32 v223, v223
  v_pk_mul_f32 v[224:225], v[224:225], v[220:221]
  v_pk_mul_f32 v[226:227], v[226:227], v[222:223]
  v_cvt_pk_bf16_f32 v242, v224, v225
  v_cvt_pk_bf16_f32 v243, v226, v227
  s_nop 0
  v_permlane16_swap_b32 v240, v242
  v_permlane16_swap_b32 v241, v243
  buffer_store_dwordx4 v[240:243], v214, s[16:19], s41 offen sc1
  s_add_u32 s41, s41, 229376
  v_permlane32_swap_b32 v80, v108
  v_permlane32_swap_b32 v81, v109
  v_permlane32_swap_b32 v82, v110
  v_permlane32_swap_b32 v83, v111
  v_pk_mul_f32 v[220:221], v[80:81], v[80:81]
  v_pk_mul_f32 v[222:223], v[82:83], v[82:83]
  v_pk_fma_f32 v[220:221], v[220:221], s[38:39], v[216:217]
  v_pk_fma_f32 v[222:223], v[222:223], s[38:39], v[216:217]
  v_pk_mul_f32 v[220:221], v[220:221], v[80:81]
  v_pk_mul_f32 v[222:223], v[222:223], v[82:83]
  v_exp_f32 v220, v220
  v_exp_f32 v221, v221
  v_exp_f32 v222, v222
  v_exp_f32 v223, v223
  v_pk_mul_f32 v[224:225], v[80:81], v[108:109]
  v_pk_mul_f32 v[226:227], v[82:83], v[110:111]
  v_pk_add_f32 v[220:221], v[220:221], v[218:219]
  v_pk_add_f32 v[222:223], v[222:223], v[218:219]
  v_rcp_f32 v220, v220
  v_rcp_f32 v221, v221
  v_rcp_f32 v222, v222
  v_rcp_f32 v223, v223
  v_pk_mul_f32 v[224:225], v[224:225], v[220:221]
  v_pk_mul_f32 v[226:227], v[226:227], v[222:223]
  v_cvt_pk_bf16_f32 v246, v224, v225
  v_cvt_pk_bf16_f32 v247, v226, v227
  s_nop 0
  v_permlane16_swap_b32 v244, v246
  v_permlane16_swap_b32 v245, v247
  buffer_store_dwordx4 v[244:247], v215, s[16:19], s42 offen sc1
  s_lshl_b32 s29, s21, 5
  s_add_u32 s29, s29, s22
  s_lshl_b32 s29, s29, 7
  s_add_u32 s29, s29, 0xc00000
  s_add_u32 s4, s36, s29
  s_addc_u32 s5, s37, 0
  s_mov_b32 s6, 0x80
  s_mov_b32 s7, 0x20000
  s_lshl_b32 s29, s20, 8
  v_lshlrev_b32 v0, 8, v208
  v_add_u32 v0, s29, v0
  v_mov_b32 v1, 1
  s_waitcnt vmcnt(0)
  s_barrier
  buffer_atomic_add v1, v0, s[4:7], 0 offen offset:124 sc1
  v_mov_b32 v140, v208
  s_mov_b64 s[34:35], s[46:47]
  s_add_u32 m0, s25, 81920
  s_add_u32 s79, s76, s77
  buffer_load_dwordx4 v255, s[72:75], s76 offen lds
  buffer_load_dwordx4 v255, s[72:75], s79 offen offset:1024 lds
  s_add_u32 s76, s76, s78
  s_add_u32 m0, s25, 114688
  s_add_u32 s79, s76, s77
  buffer_load_dwordx4 v255, s[72:75], s76 offen lds
  buffer_load_dwordx4 v255, s[72:75], s79 offen offset:1024 lds
  s_add_u32 s76, s76, s78
  s_mul_i32 s86, s20, 114688
  v_lshlrev_b32 v138, 4, v140
  v_add_u32 v138, s86, v138
  s_mul_i32 s23, s82, 57344
  s_lshl_b32 s25, s20, 11
  s_lshl_b32 s48, s83, 3
  s_add_u32 s48, s48, s84
  s_lshl_b32 s48, s48, 7
  s_add_u32 s48, s48, 0xc00000
  s_lshl_b32 s89, s20, 1
  s_sub_u32 s89, s85, s89
  v_mov_b32 v148, 1
  v_lshlrev_b32 v149, 8, v140
  s_mul_i32 s86, s83, 917504
  s_add_u32 s86, s86, 0x1800000
  s_add_u32 s4, s36, s86
  s_addc_u32 s5, s37, 0
  s_mov_b32 s6, 0xe0000
  s_mov_b32 s7, 0x20000
  s_add_u32 s64, s36, s48
  s_addc_u32 s65, s37, 0
  s_mov_b32 s66, 0x80
  s_mov_b32 s67, 0x20000
  s_cmp_eq_u32 s89, 1
  s_cbranch_scc0 mlp_g2_noticket
  buffer_atomic_add v148, v149, s[64:67], 0 offen sc0 sc1
mlp_g2_noticket:
  s_lshr_b32 s86, s20, 2
  s_bfe_u32 s87, s20, 0x10001
  s_lshl_b32 s87, s87, 13
  s_lshl_b32 s88, s86, 10
  s_add_u32 s87, s87, s88
  v_lshlrev_b32 v128, 4, v140
  v_add_u32 v128, s87, v128
  s_lshl_b32 s88, s86, 12
  v_xor_b32 v128, s88, v128
  v_add_u32 v129, 65536, v128
  v_xor_b32 v146, 4096, v128
  v_xor_b32 v147, 4096, v129
  v_lshrrev_b32 v141, 4, v140
  v_bfe_u32 v142, v140, 2, 2
  v_lshlrev_b32 v143, 11, v141
  v_lshl_add_u32 v143, v142, 8, v143
  v_and_b32 v144, 3, v140
  v_lshl_add_u32 v143, v144, 3, v143
  s_lshl_b32 s88, s86, 13
  s_add_u32 s88, s88, 16384
  v_add_u32 v143, s88, v143
  v_and_b32 v141, 1, v141
  v_lshl_add_u32 v142, v141, 2, v142
  s_and_b32 s88, s20, 1
  s_lshl_b32 s88, s88, 2
  v_xor_b32 v142, s88, v142
  v_xor_b32 v141, 0, v142
  v_lshl_add_u32 v130, v141, 5, v143
  v_add_u32 v134, 65536, v130
  v_xor_b32 v141, 1, v142
  v_lshl_add_u32 v131, v141, 5, v143
  v_add_u32 v135, 65536, v131
  v_xor_b32 v141, 2, v142
  v_lshl_add_u32 v132, v141, 5, v143
  v_add_u32 v136, 65536, v132
  v_xor_b32 v141, 3, v142
  v_lshl_add_u32 v133, v141, 5, v143
  v_add_u32 v137, 65536, v133
  s_lshr_b32 s86, s83, 1
  s_lshl_b32 s86, s86, 1
  s_add_u32 s86, s86, s82
  s_lshl_b32 s86, s86, 11
  s_add_u32 s86, s86, 0xc00000
  s_add_u32 s12, s36, s86
  s_addc_u32 s13, s37, 0
  s_mov_b32 s14, 0x800
  s_mov_b32 s15, 0x20000
  v_and_b32 v141, 15, v140
  v_lshlrev_b32 v141, 7, v141
  s_mov_b32 s27, 0x10000
mlp_g2_wait:
  buffer_load_dword v142, v141, s[12:15], 0 offen offset:124 sc1
  s_sub_u32 s27, s27, 1
  s_waitcnt vmcnt(0)
  s_cmp_eq_u32 s27, 0
  s_cbranch_scc1 mlp_g2_waited
  v_cmp_gt_u32 vcc, 1, v142
  s_nop 0
  s_cmp_lg_u64 vcc, 0
  s_cbranch_scc1 mlp_g2_wait
mlp_g2_waited:
  s_add_u32 m0, s25, 0
  s_nop 0
  buffer_load_dwordx4 v138, s[4:7], s23 offen lds
  buffer_load_dwordx4 v138, s[4:7], s23 offen offset:1024 lds
  s_add_u32 s23, s23, 2048
  s_add_u32 m0, s25, 32768
  s_nop 0
  buffer_load_dwordx4 v138, s[4:7], s23 offen lds
  buffer_load_dwordx4 v138, s[4:7], s23 offen offset:1024 lds
  s_add_u32 s23, s23, 2048
  s_add_u32 m0, s25, 65536
  s_nop 0
  buffer_load_dwordx4 v138, s[4:7], s23 offen lds
  buffer_load_dwordx4 v138, s[4:7], s23 offen offset:1024 lds
  s_add_u32 s23, s23, 2048
  s_add_u32 m0, s25, 98304
  s_nop 0
  buffer_load_dwordx4 v138, s[4:7], s23 offen lds
  buffer_load_dwordx4 v138, s[4:7], s23 offen offset:1024 lds
  s_add_u32 s23, s23, 2048
  s_waitcnt vmcnt(6)
  s_cmp_eq_u32 s89, 1
  s_cbranch_scc0 mlp_g2_norole
  v_mov_b32 v149, 131072
  s_mov_b64 exec, 1
  ds_write_b32 v149, v148
  s_mov_b64 exec, -1
  s_waitcnt lgkmcnt(0)
mlp_g2_norole:
  s_barrier
  ds_read_b64_tr_b16 v[96:97], v130 offset:0
  ds_read_b64_tr_b16 v[98:99], v130 offset:1024
  ds_read_b128 v[64:67], v128 offset:0
  ds_read_b128 v[68:71], v128 offset:2048
  ds_read_b128 v[72:75], v146 offset:0
  ds_read_b128 v[76:79], v146 offset:2048
  ds_read_b64_tr_b16 v[100:101], v131 offset:0
  ds_read_b64_tr_b16 v[102:103], v131 offset:1024
  ds_read_b64_tr_b16 v[104:105], v132 offset:0
  ds_read_b64_tr_b16 v[106:107], v132 offset:1024
  ds_read_b64_tr_b16 v[108:109], v133 offset:0
  ds_read_b64_tr_b16 v[110:111], v133 offset:1024
  s_waitcnt lgkmcnt(0)
  v_mfma_f32_16x16x32_bf16 v[0:3], v[96:99], v[64:67], 0
  v_mfma_f32_16x16x32_bf16 v[16:19], v[96:99], v[68:71], 0
  v_mfma_f32_16x16x32_bf16 v[32:35], v[96:99], v[72:75], 0
  v_mfma_f32_16x16x32_bf16 v[48:51], v[96:99], v[76:79], 0
  v_mfma_f32_16x16x32_bf16 v[52:55], v[100:103], v[76:79], 0
  v_mfma_f32_16x16x32_bf16 v[36:39], v[100:103], v[72:75], 0
  v_mfma_f32_16x16x32_bf16 v[20:23], v[100:103], v[68:71], 0
  v_mfma_f32_16x16x32_bf16 v[4:7], v[100:103], v[64:67], 0
  s_waitcnt vmcnt(2)
  s_barrier
  v_mfma_f32_16x16x32_bf16 v[8:11], v[104:107], v[64:67], 0
  ds_read_b64_tr_b16 v[112:113], v130 offset:32768
  ds_read_b64_tr_b16 v[114:115], v130 offset:33792
  v_mfma_f32_16x16x32_bf16 v[24:27], v[104:107], v[68:71], 0
  ds_read_b128 v[80:83], v128 offset:32768
  s_add_u32 m0, s25, 0
  s_nop 0
  buffer_load_dwordx4 v138, s[4:7], s23 offen lds
  v_mfma_f32_16x16x32_bf16 v[40:43], v[104:107], v[72:75], 0
  ds_read_b128 v[84:87], v128 offset:34816
  ds_read_b128 v[88:91], v146 offset:32768
  v_mfma_f32_16x16x32_bf16 v[56:59], v[104:107], v[76:79], 0
  ds_read_b128 v[92:95], v146 offset:34816
  buffer_load_dwordx4 v138, s[4:7], s23 offen offset:1024 lds
  s_add_u32 s23, s23, 2048
  v_mfma_f32_16x16x32_bf16 v[60:63], v[108:111], v[76:79], 0
  ds_read_b64_tr_b16 v[116:117], v131 offset:32768
  ds_read_b64_tr_b16 v[118:119], v131 offset:33792
  v_mfma_f32_16x16x32_bf16 v[44:47], v[108:111], v[72:75], 0
  ds_read_b64_tr_b16 v[120:121], v132 offset:32768
  s_add_u32 m0, s25, 16384
  s_add_u32 s79, s76, s77
  buffer_load_dwordx4 v255, s[72:75], s76 offen lds
  v_mfma_f32_16x16x32_bf16 v[28:31], v[108:111], v[68:71], 0
  ds_read_b64_tr_b16 v[122:123], v132 offset:33792
  ds_read_b64_tr_b16 v[124:125], v133 offset:32768
  v_mfma_f32_16x16x32_bf16 v[12:15], v[108:111], v[64:67], 0
  ds_read_b64_tr_b16 v[126:127], v133 offset:33792
  buffer_load_dwordx4 v255, s[72:75], s79 offen offset:1024 lds
  s_add_u32 s76, s76, s78
  s_mov_b32 s27, 0
.p2align 6
mlp_g2_loop:
  s_waitcnt vmcnt(8) lgkmcnt(0)
  s_barrier
  v_mfma_f32_16x16x32_bf16 v[0:3], v[112:115], v[80:83], v[0:3]
  s_add_u32 m0, s25, 32768
  s_nop 0
  buffer_load_dwordx4 v138, s[4:7], s23 offen lds
  ds_read_b64_tr_b16 v[96:97], v134 offset:0
  v_mfma_f32_16x16x32_bf16 v[16:19], v[112:115], v[84:87], v[16:19]
  ds_read_b64_tr_b16 v[98:99], v134 offset:1024
  v_mfma_f32_16x16x32_bf16 v[32:35], v[112:115], v[88:91], v[32:35]
  ds_read_b128 v[64:67], v129 offset:0
  v_mfma_f32_16x16x32_bf16 v[48:51], v[112:115], v[92:95], v[48:51]
  buffer_load_dwordx4 v138, s[4:7], s23 offen offset:1024 lds
  s_add_u32 s23, s23, 2048
  ds_read_b128 v[68:71], v129 offset:2048
  v_mfma_f32_16x16x32_bf16 v[52:55], v[116:119], v[92:95], v[52:55]
  ds_read_b128 v[72:75], v147 offset:0
  v_mfma_f32_16x16x32_bf16 v[36:39], v[116:119], v[88:91], v[36:39]
  ds_read_b128 v[76:79], v147 offset:2048
  v_mfma_f32_16x16x32_bf16 v[20:23], v[116:119], v[84:87], v[20:23]
  s_add_u32 m0, s25, 49152
  s_add_u32 s79, s76, s77
  buffer_load_dwordx4 v255, s[72:75], s76 offen lds
  ds_read_b64_tr_b16 v[100:101], v135 offset:0
  v_mfma_f32_16x16x32_bf16 v[4:7], v[116:119], v[80:83], v[4:7]
  ds_read_b64_tr_b16 v[102:103], v135 offset:1024
  v_mfma_f32_16x16x32_bf16 v[8:11], v[120:123], v[80:83], v[8:11]
  ds_read_b64_tr_b16 v[104:105], v136 offset:0
  v_mfma_f32_16x16x32_bf16 v[24:27], v[120:123], v[84:87], v[24:27]
  buffer_load_dwordx4 v255, s[72:75], s79 offen offset:1024 lds
  s_add_u32 s76, s76, s78
  ds_read_b64_tr_b16 v[106:107], v136 offset:1024
  v_mfma_f32_16x16x32_bf16 v[40:43], v[120:123], v[88:91], v[40:43]
  ds_read_b64_tr_b16 v[108:109], v137 offset:0
  v_mfma_f32_16x16x32_bf16 v[56:59], v[120:123], v[92:95], v[56:59]
  ds_read_b64_tr_b16 v[110:111], v137 offset:1024
  v_mfma_f32_16x16x32_bf16 v[60:63], v[124:127], v[92:95], v[60:63]
  v_mfma_f32_16x16x32_bf16 v[44:47], v[124:127], v[88:91], v[44:47]
  v_mfma_f32_16x16x32_bf16 v[28:31], v[124:127], v[84:87], v[28:31]
  v_mfma_f32_16x16x32_bf16 v[12:15], v[124:127], v[80:83], v[12:15]
  s_waitcnt vmcnt(8) lgkmcnt(0)
  s_barrier
  v_mfma_f32_16x16x32_bf16 v[0:3], v[96:99], v[64:67], v[0:3]
  s_add_u32 m0, s25, 65536
  s_nop 0
  buffer_load_dwordx4 v138, s[4:7], s23 offen lds
  ds_read_b64_tr_b16 v[112:113], v134 offset:32768
  v_mfma_f32_16x16x32_bf16 v[16:19], v[96:99], v[68:71], v[16:19]
  ds_read_b64_tr_b16 v[114:115], v134 offset:33792
  v_mfma_f32_16x16x32_bf16 v[32:35], v[96:99], v[72:75], v[32:35]
  ds_read_b128 v[80:83], v129 offset:32768
  v_mfma_f32_16x16x32_bf16 v[48:51], v[96:99], v[76:79], v[48:51]
  buffer_load_dwordx4 v138, s[4:7], s23 offen offset:1024 lds
  s_add_u32 s23, s23, 2048
  ds_read_b128 v[84:87], v129 offset:34816
  v_mfma_f32_16x16x32_bf16 v[52:55], v[100:103], v[76:79], v[52:55]
  ds_read_b128 v[88:91], v147 offset:32768
  v_mfma_f32_16x16x32_bf16 v[36:39], v[100:103], v[72:75], v[36:39]
  ds_read_b128 v[92:95], v147 offset:34816
  v_mfma_f32_16x16x32_bf16 v[20:23], v[100:103], v[68:71], v[20:23]
  s_add_u32 m0, s25, 81920
  s_add_u32 s79, s76, s77
  buffer_load_dwordx4 v255, s[72:75], s76 offen lds
  ds_read_b64_tr_b16 v[116:117], v135 offset:32768
  v_mfma_f32_16x16x32_bf16 v[4:7], v[100:103], v[64:67], v[4:7]
  ds_read_b64_tr_b16 v[118:119], v135 offset:33792
  v_mfma_f32_16x16x32_bf16 v[8:11], v[104:107], v[64:67], v[8:11]
  ds_read_b64_tr_b16 v[120:121], v136 offset:32768
  v_mfma_f32_16x16x32_bf16 v[24:27], v[104:107], v[68:71], v[24:27]
  buffer_load_dwordx4 v255, s[72:75], s79 offen offset:1024 lds
  s_add_u32 s76, s76, s78
  ds_read_b64_tr_b16 v[122:123], v136 offset:33792
  v_mfma_f32_16x16x32_bf16 v[40:43], v[104:107], v[72:75], v[40:43]
  ds_read_b64_tr_b16 v[124:125], v137 offset:32768
  v_mfma_f32_16x16x32_bf16 v[56:59], v[104:107], v[76:79], v[56:59]
  ds_read_b64_tr_b16 v[126:127], v137 offset:33792
  v_mfma_f32_16x16x32_bf16 v[60:63], v[108:111], v[76:79], v[60:63]
  v_mfma_f32_16x16x32_bf16 v[44:47], v[108:111], v[72:75], v[44:47]
  v_mfma_f32_16x16x32_bf16 v[28:31], v[108:111], v[68:71], v[28:31]
  v_mfma_f32_16x16x32_bf16 v[12:15], v[108:111], v[64:67], v[12:15]
  s_waitcnt vmcnt(8) lgkmcnt(0)
  s_barrier
  v_mfma_f32_16x16x32_bf16 v[0:3], v[112:115], v[80:83], v[0:3]
  s_add_u32 m0, s25, 98304
  s_nop 0
  buffer_load_dwordx4 v138, s[4:7], s23 offen lds
  ds_read_b64_tr_b16 v[96:97], v130 offset:0
  v_mfma_f32_16x16x32_bf16 v[16:19], v[112:115], v[84:87], v[16:19]
  ds_read_b64_tr_b16 v[98:99], v130 offset:1024
  v_mfma_f32_16x16x32_bf16 v[32:35], v[112:115], v[88:91], v[32:35]
  ds_read_b128 v[64:67], v128 offset:0
  v_mfma_f32_16x16x32_bf16 v[48:51], v[112:115], v[92:95], v[48:51]
  buffer_load_dwordx4 v138, s[4:7], s23 offen offset:1024 lds
  s_add_u32 s23, s23, 2048
  ds_read_b128 v[68:71], v128 offset:2048
  v_mfma_f32_16x16x32_bf16 v[52:55], v[116:119], v[92:95], v[52:55]
  ds_read_b128 v[72:75], v146 offset:0
  v_mfma_f32_16x16x32_bf16 v[36:39], v[116:119], v[88:91], v[36:39]
  ds_read_b128 v[76:79], v146 offset:2048
  v_mfma_f32_16x16x32_bf16 v[20:23], v[116:119], v[84:87], v[20:23]
  s_add_u32 m0, s25, 114688
  s_add_u32 s79, s76, s77
  buffer_load_dwordx4 v255, s[72:75], s76 offen lds
  ds_read_b64_tr_b16 v[100:101], v131 offset:0
  v_mfma_f32_16x16x32_bf16 v[4:7], v[116:119], v[80:83], v[4:7]
  ds_read_b64_tr_b16 v[102:103], v131 offset:1024
  v_mfma_f32_16x16x32_bf16 v[8:11], v[120:123], v[80:83], v[8:11]
  ds_read_b64_tr_b16 v[104:105], v132 offset:0
  v_mfma_f32_16x16x32_bf16 v[24:27], v[120:123], v[84:87], v[24:27]
  buffer_load_dwordx4 v255, s[72:75], s79 offen offset:1024 lds
  s_add_u32 s76, s76, s78
  ds_read_b64_tr_b16 v[106:107], v132 offset:1024
  v_mfma_f32_16x16x32_bf16 v[40:43], v[120:123], v[88:91], v[40:43]
  ds_read_b64_tr_b16 v[108:109], v133 offset:0
  v_mfma_f32_16x16x32_bf16 v[56:59], v[120:123], v[92:95], v[56:59]
  ds_read_b64_tr_b16 v[110:111], v133 offset:1024
  v_mfma_f32_16x16x32_bf16 v[60:63], v[124:127], v[92:95], v[60:63]
  v_mfma_f32_16x16x32_bf16 v[44:47], v[124:127], v[88:91], v[44:47]
  v_mfma_f32_16x16x32_bf16 v[28:31], v[124:127], v[84:87], v[28:31]
  v_mfma_f32_16x16x32_bf16 v[12:15], v[124:127], v[80:83], v[12:15]
  s_cmp_eq_u32 s27, 2
  s_cselect_b32 s76, s80, s76
  s_cselect_b32 s77, 7168, s77
  s_cselect_b32 s78, 458752, s78
  s_cmp_eq_u32 s27, 4
  s_cselect_b32 s76, s81, s76
  s_cselect_b32 s77, 7168, s77
  s_cselect_b32 s78, 917504, s78
  s_cmp_eq_u32 s27, 5
  s_cselect_b32 s76, 0x40000000, s76
  s_cselect_b32 s23, 0x40000000, s23
  s_waitcnt vmcnt(8) lgkmcnt(0)
  s_barrier
  v_mfma_f32_16x16x32_bf16 v[0:3], v[96:99], v[64:67], v[0:3]
  s_add_u32 m0, s25, 0
  s_nop 0
  buffer_load_dwordx4 v138, s[4:7], s23 offen lds
  ds_read_b64_tr_b16 v[112:113], v130 offset:32768
  v_mfma_f32_16x16x32_bf16 v[16:19], v[96:99], v[68:71], v[16:19]
  ds_read_b64_tr_b16 v[114:115], v130 offset:33792
  v_mfma_f32_16x16x32_bf16 v[32:35], v[96:99], v[72:75], v[32:35]
  ds_read_b128 v[80:83], v128 offset:32768
  v_mfma_f32_16x16x32_bf16 v[48:51], v[96:99], v[76:79], v[48:51]
  buffer_load_dwordx4 v138, s[4:7], s23 offen offset:1024 lds
  s_add_u32 s23, s23, 2048
  ds_read_b128 v[84:87], v128 offset:34816
  v_mfma_f32_16x16x32_bf16 v[52:55], v[100:103], v[76:79], v[52:55]
  ds_read_b128 v[88:91], v146 offset:32768
  v_mfma_f32_16x16x32_bf16 v[36:39], v[100:103], v[72:75], v[36:39]
  ds_read_b128 v[92:95], v146 offset:34816
  v_mfma_f32_16x16x32_bf16 v[20:23], v[100:103], v[68:71], v[20:23]
  s_add_u32 m0, s25, 16384
  s_add_u32 s79, s76, s77
  buffer_load_dwordx4 v255, s[72:75], s76 offen lds
  ds_read_b64_tr_b16 v[116:117], v131 offset:32768
  v_mfma_f32_16x16x32_bf16 v[4:7], v[100:103], v[64:67], v[4:7]
  ds_read_b64_tr_b16 v[118:119], v131 offset:33792
  v_mfma_f32_16x16x32_bf16 v[8:11], v[104:107], v[64:67], v[8:11]
  ds_read_b64_tr_b16 v[120:121], v132 offset:32768
  v_mfma_f32_16x16x32_bf16 v[24:27], v[104:107], v[68:71], v[24:27]
  buffer_load_dwordx4 v255, s[72:75], s79 offen offset:1024 lds
  s_add_u32 s76, s76, s78
  ds_read_b64_tr_b16 v[122:123], v132 offset:33792
  v_mfma_f32_16x16x32_bf16 v[40:43], v[104:107], v[72:75], v[40:43]
  ds_read_b64_tr_b16 v[124:125], v133 offset:32768
  v_mfma_f32_16x16x32_bf16 v[56:59], v[104:107], v[76:79], v[56:59]
  ds_read_b64_tr_b16 v[126:127], v133 offset:33792
  v_mfma_f32_16x16x32_bf16 v[60:63], v[108:111], v[76:79], v[60:63]
  v_mfma_f32_16x16x32_bf16 v[44:47], v[108:111], v[72:75], v[44:47]
  v_mfma_f32_16x16x32_bf16 v[28:31], v[108:111], v[68:71], v[28:31]
  v_mfma_f32_16x16x32_bf16 v[12:15], v[108:111], v[64:67], v[12:15]
  s_add_u32 s27, s27, 1
  s_cmp_lg_u32 s27, 6
  s_cbranch_scc1 mlp_g2_loop
  s_waitcnt vmcnt(8) lgkmcnt(0)
  s_barrier
  v_mfma_f32_16x16x32_bf16 v[0:3], v[112:115], v[80:83], v[0:3]
  ds_read_b64_tr_b16 v[96:97], v134 offset:0
  v_mfma_f32_16x16x32_bf16 v[16:19], v[112:115], v[84:87], v[16:19]
  ds_read_b64_tr_b16 v[98:99], v134 offset:1024
  s_lshr_b32 s86, s83, 1
  v_mfma_f32_16x16x32_bf16 v[32:35], v[112:115], v[88:91], v[32:35]
  ds_read_b128 v[64:67], v129 offset:0
  v_mfma_f32_16x16x32_bf16 v[48:51], v[112:115], v[92:95], v[48:51]
  ds_read_b128 v[68:71], v129 offset:2048
  s_lshl_b32 s86, s86, 8
  v_mfma_f32_16x16x32_bf16 v[52:55], v[116:119], v[92:95], v[52:55]
  ds_read_b128 v[72:75], v147 offset:0
  v_mfma_f32_16x16x32_bf16 v[36:39], v[116:119], v[88:91], v[36:39]
  ds_read_b128 v[76:79], v147 offset:2048
  s_lshl_b32 s87, s83, 2
  v_mfma_f32_16x16x32_bf16 v[20:23], v[116:119], v[84:87], v[20:23]
  ds_read_b64_tr_b16 v[100:101], v135 offset:0
  v_mfma_f32_16x16x32_bf16 v[4:7], v[116:119], v[80:83], v[4:7]
  ds_read_b64_tr_b16 v[102:103], v135 offset:1024
  s_bfe_u32 s88, s20, 0x10001
  v_mfma_f32_16x16x32_bf16 v[8:11], v[120:123], v[80:83], v[8:11]
  ds_read_b64_tr_b16 v[104:105], v136 offset:0
  v_mfma_f32_16x16x32_bf16 v[24:27], v[120:123], v[84:87], v[24:27]
  ds_read_b64_tr_b16 v[106:107], v136 offset:1024
  s_lshl_b32 s88, s88, 1
  v_mfma_f32_16x16x32_bf16 v[40:43], v[120:123], v[88:91], v[40:43]
  ds_read_b64_tr_b16 v[108:109], v137 offset:0
  v_mfma_f32_16x16x32_bf16 v[56:59], v[120:123], v[92:95], v[56:59]
  ds_read_b64_tr_b16 v[110:111], v137 offset:1024
  s_add_u32 s87, s87, s88
  v_mfma_f32_16x16x32_bf16 v[60:63], v[124:127], v[92:95], v[60:63]
  v_mfma_f32_16x16x32_bf16 v[44:47], v[124:127], v[88:91], v[44:47]
  v_mov_b32 v149, 131072
  v_mfma_f32_16x16x32_bf16 v[28:31], v[124:127], v[84:87], v[28:31]
  v_mfma_f32_16x16x32_bf16 v[12:15], v[124:127], v[80:83], v[12:15]
  ds_read_b32 v148, v149
  s_waitcnt vmcnt(0) lgkmcnt(0)
  s_barrier
  v_mfma_f32_16x16x32_bf16 v[0:3], v[96:99], v[64:67], v[0:3]
  ds_read_b64_tr_b16 v[112:113], v134 offset:32768
  v_mfma_f32_16x16x32_bf16 v[16:19], v[96:99], v[68:71], v[16:19]
  ds_read_b64_tr_b16 v[114:115], v134 offset:33792
  s_lshr_b32 s88, s20, 2
  v_mfma_f32_16x16x32_bf16 v[32:35], v[96:99], v[72:75], v[32:35]
  ds_read_b128 v[80:83], v129 offset:32768
  v_mfma_f32_16x16x32_bf16 v[48:51], v[96:99], v[76:79], v[48:51]
  ds_read_b128 v[84:87], v129 offset:34816
  s_add_u32 s87, s87, s88
  v_mfma_f32_16x16x32_bf16 v[52:55], v[100:103], v[76:79], v[52:55]
  ds_read_b128 v[88:91], v147 offset:32768
  v_mfma_f32_16x16x32_bf16 v[36:39], v[100:103], v[72:75], v[36:39]
  ds_read_b128 v[92:95], v147 offset:34816
  s_and_b32 s87, s87, 7
  v_mfma_f32_16x16x32_bf16 v[20:23], v[100:103], v[68:71], v[20:23]
  ds_read_b64_tr_b16 v[116:117], v135 offset:32768
  v_mfma_f32_16x16x32_bf16 v[4:7], v[100:103], v[64:67], v[4:7]
  ds_read_b64_tr_b16 v[118:119], v135 offset:33792
  s_add_u32 s86, s86, s87
  v_mfma_f32_16x16x32_bf16 v[8:11], v[104:107], v[64:67], v[8:11]
  ds_read_b64_tr_b16 v[120:121], v136 offset:32768
  v_mfma_f32_16x16x32_bf16 v[24:27], v[104:107], v[68:71], v[24:27]
  ds_read_b64_tr_b16 v[122:123], v136 offset:33792
  s_lshl_b32 s86, s86, 11
  v_mfma_f32_16x16x32_bf16 v[40:43], v[104:107], v[72:75], v[40:43]
  ds_read_b64_tr_b16 v[124:125], v137 offset:32768
  v_mfma_f32_16x16x32_bf16 v[56:59], v[104:107], v[76:79], v[56:59]
  ds_read_b64_tr_b16 v[126:127], v137 offset:33792
  s_lshl_b32 s87, s84, 8
  v_mfma_f32_16x16x32_bf16 v[60:63], v[108:111], v[76:79], v[60:63]
  v_mfma_f32_16x16x32_bf16 v[44:47], v[108:111], v[72:75], v[44:47]
  s_add_u32 s86, s86, s87
  v_mfma_f32_16x16x32_bf16 v[28:31], v[108:111], v[68:71], v[28:31]
  v_mfma_f32_16x16x32_bf16 v[12:15], v[108:111], v[64:67], v[12:15]
  v_readfirstlane_b32 s90, v148
  s_and_b32 s87, s20, 1
  s_lshl_b32 s87, s87, 7
  s_add_u32 s86, s86, s87
  v_and_b32 v141, 15, v140
  v_lshlrev_b32 v145, 14, v141
  v_bfe_u32 v141, v140, 4, 1
  v_lshl_add_u32 v145, v141, 5, v145
  v_lshrrev_b32 v141, 5, v140
  v_lshl_add_u32 v145, v141, 4, v145
  v_add_u32 v145, s86, v145
  s_xor_b32 s87, s82, 1
  s_and_b32 s90, s90, 1
  s_cmp_eq_u32 s85, 0
  s_cselect_b32 s90, s87, s90
  s_add_u32 s40, s36, 0x400000
  s_addc_u32 s41, s37, 0
  s_cmp_eq_u32 s85, 0
  s_cselect_b32 s34, s40, s34
  s_cselect_b32 s35, s41, s35
  s_mul_i32 s87, s85, 37748736
  s_add_u32 s87, s87, 0x1000000
  s_add_u32 s40, s36, s87
  s_addc_u32 s41, s37, 0
  s_cmp_eq_u32 s90, 0
  s_cselect_b32 s34, s40, s34
  s_cselect_b32 s35, s41, s35
  s_mov_b32 s16, s34
  s_mov_b32 s17, s35
  s_mov_b32 s18, 0x400000
  s_mov_b32 s19, 0x20000
  s_mul_i32 s87, s85, 46137344
  s_add_u32 s87, s87, 0x400000
  s_add_u32 s12, s36, s87
  s_addc_u32 s13, s37, 0
  s_mov_b32 s14, 0x400000
  s_mov_b32 s15, 0x20000
  s_mov_b32 s4, s40
  s_mov_b32 s5, s41
  s_mov_b32 s6, 0x400000
  s_mov_b32 s7, 0x20000
  s_lshl_b32 s14, s90, 22
  s_mov_b32 s87, 262144
  s_waitcnt vmcnt(63) lgkmcnt(0)
  v_mfma_f32_16x16x32_bf16 v[0:3], v[112:115], v[80:83], v[0:3]
  v_mfma_f32_16x16x32_bf16 v[16:19], v[112:115], v[84:87], v[16:19]
  buffer_load_dwordx4 v[152:155], v145, s[12:15], 0 offen offset:0
  v_mfma_f32_16x16x32_bf16 v[32:35], v[112:115], v[88:91], v[32:35]
  v_mfma_f32_16x16x32_bf16 v[48:51], v[112:115], v[92:95], v[48:51]
  buffer_load_dwordx4 v[156:159], v145, s[12:15], 0 offen offset:64
  v_mfma_f32_16x16x32_bf16 v[52:55], v[116:119], v[92:95], v[52:55]
  v_mfma_f32_16x16x32_bf16 v[36:39], v[116:119], v[88:91], v[36:39]
  buffer_load_dwordx4 v[160:163], v145, s[12:15], s87 offen offset:0
  v_mfma_f32_16x16x32_bf16 v[20:23], v[116:119], v[84:87], v[20:23]
  v_mfma_f32_16x16x32_bf16 v[4:7], v[116:119], v[80:83], v[4:7]
  buffer_load_dwordx4 v[164:167], v145, s[12:15], s87 offen offset:64
  v_mfma_f32_16x16x32_bf16 v[8:11], v[120:123], v[80:83], v[8:11]
  v_mfma_f32_16x16x32_bf16 v[24:27], v[120:123], v[84:87], v[24:27]
  v_mfma_f32_16x16x32_bf16 v[40:43], v[120:123], v[88:91], v[40:43]
  v_mfma_f32_16x16x32_bf16 v[56:59], v[120:123], v[92:95], v[56:59]
  v_mfma_f32_16x16x32_bf16 v[60:63], v[124:127], v[92:95], v[60:63]
  v_mfma_f32_16x16x32_bf16 v[44:47], v[124:127], v[88:91], v[44:47]
  v_mfma_f32_16x16x32_bf16 v[28:31], v[124:127], v[84:87], v[28:31]
  v_mfma_f32_16x16x32_bf16 v[12:15], v[124:127], v[80:83], v[12:15]
  s_lshl_b32 s86, s20, 13
  v_lshlrev_b32 v141, 4, v140
  v_add_u32 v141, s86, v141
  v_xor_b32 v142, 32768, v141
  ds_write_b128 v141, v[32:35] offset:0
  ds_write_b128 v141, v[36:39] offset:1024
  ds_write_b128 v141, v[40:43] offset:2048
  ds_write_b128 v141, v[44:47] offset:3072
  ds_write_b128 v141, v[48:51] offset:4096
  ds_write_b128 v141, v[52:55] offset:5120
  ds_write_b128 v141, v[56:59] offset:6144
  ds_write_b128 v141, v[60:63] offset:7168
  s_waitcnt lgkmcnt(0)
  s_barrier
  ds_read_b128 v[64:67], v142 offset:0
  ds_read_b128 v[68:71], v142 offset:1024
  ds_read_b128 v[72:75], v142 offset:2048
  ds_read_b128 v[76:79], v142 offset:3072
  ds_read_b128 v[80:83], v142 offset:4096
  ds_read_b128 v[84:87], v142 offset:5120
  ds_read_b128 v[88:91], v142 offset:6144
  ds_read_b128 v[92:95], v142 offset:7168
  s_and_b32 s86, s85, s90
  s_cmp_eq_u32 s86, 1
  s_cbranch_scc0 mlp_g2_nowait
  s_lshl_b32 s88, s20, 2
  s_add_u32 s88, s88, 64
  v_mov_b32 v149, s88
  s_mov_b32 s27, 0x10000
mlp_g2_poll:
  buffer_load_dword v148, v149, s[64:67], 0 offen sc1
  s_sub_u32 s27, s27, 1
  s_waitcnt vmcnt(0)
  v_readfirstlane_b32 s88, v148
  s_cmp_eq_u32 s27, 0
  s_cselect_b32 s88, 1, s88
  s_cmp_eq_u32 s88, 0
  s_cbranch_scc1 mlp_g2_poll
  buffer_load_dwordx4 v[32:35], v145, s[4:7], 0 offen offset:0 sc1
  buffer_load_dwordx4 v[36:39], v145, s[4:7], 0 offen offset:64 sc1
  buffer_load_dwordx4 v[40:43], v145, s[4:7], s87 offen offset:0 sc1
  buffer_load_dwordx4 v[44:47], v145, s[4:7], s87 offen offset:64 sc1
  s_branch mlp_g2_sum
mlp_g2_nowait:
  v_mov_b32 v32, 0
  v_mov_b32 v33, 0
  v_mov_b32 v34, 0
  v_mov_b32 v35, 0
  v_mov_b32 v36, 0
  v_mov_b32 v37, 0
  v_mov_b32 v38, 0
  v_mov_b32 v39, 0
  v_mov_b32 v40, 0
  v_mov_b32 v41, 0
  v_mov_b32 v42, 0
  v_mov_b32 v43, 0
  v_mov_b32 v44, 0
  v_mov_b32 v45, 0
  v_mov_b32 v46, 0
  v_mov_b32 v47, 0
mlp_g2_sum:
  s_waitcnt lgkmcnt(6)
  v_pk_add_f32 v[0:1], v[0:1], v[64:65]
  v_pk_add_f32 v[2:3], v[2:3], v[66:67]
  v_pk_add_f32 v[4:5], v[4:5], v[68:69]
  v_pk_add_f32 v[6:7], v[6:7], v[70:71]
  s_nop 0
  v_permlane16_swap_b32 v0, v4
  v_permlane16_swap_b32 v1, v5
  v_permlane16_swap_b32 v2, v6
  v_permlane16_swap_b32 v3, v7
  s_waitcnt lgkmcnt(4)
  v_pk_add_f32 v[8:9], v[8:9], v[72:73]
  v_pk_add_f32 v[10:11], v[10:11], v[74:75]
  v_pk_add_f32 v[12:13], v[12:13], v[76:77]
  v_pk_add_f32 v[14:15], v[14:15], v[78:79]
  s_nop 0
  v_permlane16_swap_b32 v8, v12
  v_permlane16_swap_b32 v9, v13
  v_permlane16_swap_b32 v10, v14
  v_permlane16_swap_b32 v11, v15
  s_waitcnt lgkmcnt(2)
  v_pk_add_f32 v[16:17], v[16:17], v[80:81]
  v_pk_add_f32 v[18:19], v[18:19], v[82:83]
  v_pk_add_f32 v[20:21], v[20:21], v[84:85]
  v_pk_add_f32 v[22:23], v[22:23], v[86:87]
  s_nop 0
  v_permlane16_swap_b32 v16, v20
  v_permlane16_swap_b32 v17, v21
  v_permlane16_swap_b32 v18, v22
  v_permlane16_swap_b32 v19, v23
  s_waitcnt lgkmcnt(0)
  v_pk_add_f32 v[24:25], v[24:25], v[88:89]
  v_pk_add_f32 v[26:27], v[26:27], v[90:91]
  v_pk_add_f32 v[28:29], v[28:29], v[92:93]
  v_pk_add_f32 v[30:31], v[30:31], v[94:95]
  s_nop 0
  v_permlane16_swap_b32 v24, v28
  v_permlane16_swap_b32 v25, v29
  v_permlane16_swap_b32 v26, v30
  v_permlane16_swap_b32 v27, v31
  s_cmp_eq_u32 s86, 1
  s_cbranch_scc0 mlp_g2_noround
  v_cvt_pk_bf16_f32 v96, v0, v1
  v_cvt_pk_bf16_f32 v97, v2, v3
  v_cvt_pk_bf16_f32 v98, v4, v5
  v_cvt_pk_bf16_f32 v99, v6, v7
  v_cvt_pk_bf16_f32 v100, v8, v9
  v_cvt_pk_bf16_f32 v101, v10, v11
  v_cvt_pk_bf16_f32 v102, v12, v13
  v_cvt_pk_bf16_f32 v103, v14, v15
  v_cvt_pk_bf16_f32 v104, v16, v17
  v_cvt_pk_bf16_f32 v105, v18, v19
  v_cvt_pk_bf16_f32 v106, v20, v21
  v_cvt_pk_bf16_f32 v107, v22, v23
  v_cvt_pk_bf16_f32 v108, v24, v25
  v_cvt_pk_bf16_f32 v109, v26, v27
  v_cvt_pk_bf16_f32 v110, v28, v29
  v_cvt_pk_bf16_f32 v111, v30, v31
  v_lshlrev_b32 v0, 16, v96
  v_and_b32 v1, 0xffff0000, v96
  v_lshlrev_b32 v2, 16, v97
  v_and_b32 v3, 0xffff0000, v97
  v_lshlrev_b32 v4, 16, v98
  v_and_b32 v5, 0xffff0000, v98
  v_lshlrev_b32 v6, 16, v99
  v_and_b32 v7, 0xffff0000, v99
  v_lshlrev_b32 v8, 16, v100
  v_and_b32 v9, 0xffff0000, v100
  v_lshlrev_b32 v10, 16, v101
  v_and_b32 v11, 0xffff0000, v101
  v_lshlrev_b32 v12, 16, v102
  v_and_b32 v13, 0xffff0000, v102
  v_lshlrev_b32 v14, 16, v103
  v_and_b32 v15, 0xffff0000, v103
  v_lshlrev_b32 v16, 16, v104
  v_and_b32 v17, 0xffff0000, v104
  v_lshlrev_b32 v18, 16, v105
  v_and_b32 v19, 0xffff0000, v105
  v_lshlrev_b32 v20, 16, v106
  v_and_b32 v21, 0xffff0000, v106
  v_lshlrev_b32 v22, 16, v107
  v_and_b32 v23, 0xffff0000, v107
  v_lshlrev_b32 v24, 16, v108
  v_and_b32 v25, 0xffff0000, v108
  v_lshlrev_b32 v26, 16, v109
  v_and_b32 v27, 0xffff0000, v109
  v_lshlrev_b32 v28, 16, v110
  v_and_b32 v29, 0xffff0000, v110
  v_lshlrev_b32 v30, 16, v111
  v_and_b32 v31, 0xffff0000, v111
mlp_g2_noround:
  s_waitcnt vmcnt(0)
  v_lshlrev_b32 v112, 16, v32
  v_and_b32 v113, 0xffff0000, v32
  v_lshlrev_b32 v114, 16, v33
  v_and_b32 v115, 0xffff0000, v33
  v_lshlrev_b32 v116, 16, v34
  v_and_b32 v117, 0xffff0000, v34
  v_lshlrev_b32 v118, 16, v35
  v_and_b32 v119, 0xffff0000, v35
  v_pk_add_f32 v[0:1], v[112:113], v[0:1]
  v_pk_add_f32 v[2:3], v[114:115], v[2:3]
  v_pk_add_f32 v[4:5], v[116:117], v[4:5]
  v_pk_add_f32 v[6:7], v[118:119], v[6:7]
  v_lshlrev_b32 v112, 16, v152
  v_and_b32 v113, 0xffff0000, v152
  v_lshlrev_b32 v114, 16, v153
  v_and_b32 v115, 0xffff0000, v153
  v_lshlrev_b32 v116, 16, v154
  v_and_b32 v117, 0xffff0000, v154
  v_lshlrev_b32 v118, 16, v155
  v_and_b32 v119, 0xffff0000, v155
  v_pk_add_f32 v[0:1], v[112:113], v[0:1]
  v_pk_add_f32 v[2:3], v[114:115], v[2:3]
  v_pk_add_f32 v[4:5], v[116:117], v[4:5]
  v_pk_add_f32 v[6:7], v[118:119], v[6:7]
  v_cvt_pk_bf16_f32 v96, v0, v1
  v_cvt_pk_bf16_f32 v97, v2, v3
  v_cvt_pk_bf16_f32 v98, v4, v5
  v_cvt_pk_bf16_f32 v99, v6, v7
  buffer_store_dwordx4 v[96:99], v145, s[16:19], 0 offen offset:0 sc1
  v_lshlrev_b32 v112, 16, v36
  v_and_b32 v113, 0xffff0000, v36
  v_lshlrev_b32 v114, 16, v37
  v_and_b32 v115, 0xffff0000, v37
  v_lshlrev_b32 v116, 16, v38
  v_and_b32 v117, 0xffff0000, v38
  v_lshlrev_b32 v118, 16, v39
  v_and_b32 v119, 0xffff0000, v39
  v_pk_add_f32 v[8:9], v[112:113], v[8:9]
  v_pk_add_f32 v[10:11], v[114:115], v[10:11]
  v_pk_add_f32 v[12:13], v[116:117], v[12:13]
  v_pk_add_f32 v[14:15], v[118:119], v[14:15]
  v_lshlrev_b32 v112, 16, v156
  v_and_b32 v113, 0xffff0000, v156
  v_lshlrev_b32 v114, 16, v157
  v_and_b32 v115, 0xffff0000, v157
  v_lshlrev_b32 v116, 16, v158
  v_and_b32 v117, 0xffff0000, v158
  v_lshlrev_b32 v118, 16, v159
  v_and_b32 v119, 0xffff0000, v159
  v_pk_add_f32 v[8:9], v[112:113], v[8:9]
  v_pk_add_f32 v[10:11], v[114:115], v[10:11]
  v_pk_add_f32 v[12:13], v[116:117], v[12:13]
  v_pk_add_f32 v[14:15], v[118:119], v[14:15]
  v_cvt_pk_bf16_f32 v100, v8, v9
  v_cvt_pk_bf16_f32 v101, v10, v11
  v_cvt_pk_bf16_f32 v102, v12, v13
  v_cvt_pk_bf16_f32 v103, v14, v15
  buffer_store_dwordx4 v[100:103], v145, s[16:19], 0 offen offset:64 sc1
  v_lshlrev_b32 v112, 16, v40
  v_and_b32 v113, 0xffff0000, v40
  v_lshlrev_b32 v114, 16, v41
  v_and_b32 v115, 0xffff0000, v41
  v_lshlrev_b32 v116, 16, v42
  v_and_b32 v117, 0xffff0000, v42
  v_lshlrev_b32 v118, 16, v43
  v_and_b32 v119, 0xffff0000, v43
  v_pk_add_f32 v[16:17], v[112:113], v[16:17]
  v_pk_add_f32 v[18:19], v[114:115], v[18:19]
  v_pk_add_f32 v[20:21], v[116:117], v[20:21]
  v_pk_add_f32 v[22:23], v[118:119], v[22:23]
  v_lshlrev_b32 v112, 16, v160
  v_and_b32 v113, 0xffff0000, v160
  v_lshlrev_b32 v114, 16, v161
  v_and_b32 v115, 0xffff0000, v161
  v_lshlrev_b32 v116, 16, v162
  v_and_b32 v117, 0xffff0000, v162
  v_lshlrev_b32 v118, 16, v163
  v_and_b32 v119, 0xffff0000, v163
  v_pk_add_f32 v[16:17], v[112:113], v[16:17]
  v_pk_add_f32 v[18:19], v[114:115], v[18:19]
  v_pk_add_f32 v[20:21], v[116:117], v[20:21]
  v_pk_add_f32 v[22:23], v[118:119], v[22:23]
  v_cvt_pk_bf16_f32 v104, v16, v17
  v_cvt_pk_bf16_f32 v105, v18, v19
  v_cvt_pk_bf16_f32 v106, v20, v21
  v_cvt_pk_bf16_f32 v107, v22, v23
  buffer_store_dwordx4 v[104:107], v145, s[16:19], s87 offen offset:0 sc1
  v_lshlrev_b32 v112, 16, v44
  v_and_b32 v113, 0xffff0000, v44
  v_lshlrev_b32 v114, 16, v45
  v_and_b32 v115, 0xffff0000, v45
  v_lshlrev_b32 v116, 16, v46
  v_and_b32 v117, 0xffff0000, v46
  v_lshlrev_b32 v118, 16, v47
  v_and_b32 v119, 0xffff0000, v47
  v_pk_add_f32 v[24:25], v[112:113], v[24:25]
  v_pk_add_f32 v[26:27], v[114:115], v[26:27]
  v_pk_add_f32 v[28:29], v[116:117], v[28:29]
  v_pk_add_f32 v[30:31], v[118:119], v[30:31]
  v_lshlrev_b32 v112, 16, v164
  v_and_b32 v113, 0xffff0000, v164
  v_lshlrev_b32 v114, 16, v165
  v_and_b32 v115, 0xffff0000, v165
  v_lshlrev_b32 v116, 16, v166
  v_and_b32 v117, 0xffff0000, v166
  v_lshlrev_b32 v118, 16, v167
  v_and_b32 v119, 0xffff0000, v167
  v_pk_add_f32 v[24:25], v[112:113], v[24:25]
  v_pk_add_f32 v[26:27], v[114:115], v[26:27]
  v_pk_add_f32 v[28:29], v[116:117], v[28:29]
  v_pk_add_f32 v[30:31], v[118:119], v[30:31]
  v_cvt_pk_bf16_f32 v108, v24, v25
  v_cvt_pk_bf16_f32 v109, v26, v27
  v_cvt_pk_bf16_f32 v110, v28, v29
  v_cvt_pk_bf16_f32 v111, v30, v31
  buffer_store_dwordx4 v[108:111], v145, s[16:19], s87 offen offset:64 sc1
  s_cmp_gt_u32 s85, s90
  s_cbranch_scc0 mlp_g2_done
  s_lshl_b32 s88, s20, 2
  s_add_u32 s88, s88, 64
  v_lshlrev_b32 v149, 8, v140
  v_add_u32 v149, s88, v149
  v_mov_b32 v148, 1
  s_waitcnt vmcnt(0)
  buffer_store_dword v148, v149, s[64:67], 0 offen sc1
mlp_g2_done:
mlp_end:
  s_endpgm
.p2align 8
.globl l2_kernel
.type l2_kernel,@function
l2_kernel:
  s_cmp_ge_u32 s2, 256
  s_cbranch_scc1 l2_kernel_end
  s_mov_b32 s94, 1
  v_mov_b32 v250, v0
  s_branch p1_fused
l2_kernel_end:
  s_endpgm
.p2align 8
.globl l1_kernel
.type l1_kernel,@function
l1_kernel:
  s_cmp_ge_u32 s2, 256
  s_cbranch_scc1 l1_kernel_end
  s_load_dwordx4 s[76:79], s[0:1], 32
  s_mov_b32 s94, 2
  v_mov_b32 v250, v0
  s_branch p2_fused
l1_kernel_end:
  s_endpgm
.section .rodata,"a"
.p2align 6
.amdhsa_kernel p1a_kernel
  .amdhsa_next_free_vgpr 124
  .amdhsa_next_free_sgpr 96
  .amdhsa_accum_offset 124
  .amdhsa_group_segment_fixed_size 0
  .amdhsa_kernarg_size 80
  .amdhsa_user_sgpr_count 2
  .amdhsa_user_sgpr_kernarg_segment_ptr 1
  .amdhsa_system_sgpr_workgroup_id_x 1
  .amdhsa_float_denorm_mode_32 3
.end_amdhsa_kernel
.p2align 6
.amdhsa_kernel p1b_kernel
  .amdhsa_next_free_vgpr 124
  .amdhsa_next_free_sgpr 96
  .amdhsa_accum_offset 124
  .amdhsa_group_segment_fixed_size 0
  .amdhsa_kernarg_size 80
  .amdhsa_user_sgpr_count 2
  .amdhsa_user_sgpr_kernarg_segment_ptr 1
  .amdhsa_system_sgpr_workgroup_id_x 1
  .amdhsa_float_denorm_mode_32 3
.end_amdhsa_kernel
.p2align 6
.amdhsa_kernel p2a_kernel
  .amdhsa_next_free_vgpr 96
  .amdhsa_next_free_sgpr 96
  .amdhsa_accum_offset 96
  .amdhsa_group_segment_fixed_size 0
  .amdhsa_kernarg_size 80
  .amdhsa_user_sgpr_count 2
  .amdhsa_user_sgpr_kernarg_segment_ptr 1
  .amdhsa_system_sgpr_workgroup_id_x 1
  .amdhsa_float_denorm_mode_32 3
.end_amdhsa_kernel
.p2align 6
.amdhsa_kernel p2b_kernel
  .amdhsa_next_free_vgpr 96
  .amdhsa_next_free_sgpr 96
  .amdhsa_accum_offset 96
  .amdhsa_group_segment_fixed_size 0
  .amdhsa_kernarg_size 80
  .amdhsa_user_sgpr_count 2
  .amdhsa_user_sgpr_kernarg_segment_ptr 1
  .amdhsa_system_sgpr_workgroup_id_x 1
  .amdhsa_float_denorm_mode_32 3
.end_amdhsa_kernel
.p2align 6
.amdhsa_kernel p3a_kernel
  .amdhsa_next_free_vgpr 128
  .amdhsa_next_free_sgpr 96
  .amdhsa_accum_offset 128
  .amdhsa_group_segment_fixed_size 0
  .amdhsa_kernarg_size 80
  .amdhsa_user_sgpr_count 2
  .amdhsa_user_sgpr_kernarg_segment_ptr 1
  .amdhsa_system_sgpr_workgroup_id_x 1
  .amdhsa_float_denorm_mode_32 3
.end_amdhsa_kernel
.p2align 6
.amdhsa_kernel p3b_kernel
  .amdhsa_next_free_vgpr 128
  .amdhsa_next_free_sgpr 96
  .amdhsa_accum_offset 128
  .amdhsa_group_segment_fixed_size 0
  .amdhsa_kernarg_size 80
  .amdhsa_user_sgpr_count 2
  .amdhsa_user_sgpr_kernarg_segment_ptr 1
  .amdhsa_system_sgpr_workgroup_id_x 1
  .amdhsa_float_denorm_mode_32 3
.end_amdhsa_kernel
.p2align 6
.amdhsa_kernel mlpa_kernel
  .amdhsa_next_free_vgpr 256
  .amdhsa_next_free_sgpr 96
  .amdhsa_accum_offset 256
  .amdhsa_group_segment_fixed_size 0
  .amdhsa_kernarg_size 80
  .amdhsa_user_sgpr_count 2
  .amdhsa_user_sgpr_kernarg_segment_ptr 1
  .amdhsa_system_sgpr_workgroup_id_x 1
  .amdhsa_float_denorm_mode_32 3
.end_amdhsa_kernel
.p2align 6
.amdhsa_kernel mlpb_kernel
  .amdhsa_next_free_vgpr 256
  .amdhsa_next_free_sgpr 96
  .amdhsa_accum_offset 256
  .amdhsa_group_segment_fixed_size 0
  .amdhsa_kernarg_size 80
  .amdhsa_user_sgpr_count 2
  .amdhsa_user_sgpr_kernarg_segment_ptr 1
  .amdhsa_system_sgpr_workgroup_id_x 1
  .amdhsa_float_denorm_mode_32 3
.end_amdhsa_kernel
.p2align 6
.amdhsa_kernel l2_kernel
  .amdhsa_next_free_vgpr 256
  .amdhsa_next_free_sgpr 96
  .amdhsa_accum_offset 256
  .amdhsa_group_segment_fixed_size 0
  .amdhsa_kernarg_size 80
  .amdhsa_user_sgpr_count 2
  .amdhsa_user_sgpr_kernarg_segment_ptr 1
  .amdhsa_system_sgpr_workgroup_id_x 1
  .amdhsa_float_denorm_mode_32 3
.end_amdhsa_kernel
.p2align 6
.amdhsa_kernel l1_kernel
  .amdhsa_next_free_vgpr 256
  .amdhsa_next_free_sgpr 96
  .amdhsa_accum_offset 256
  .amdhsa_group_segment_fixed_size 0
  .amdhsa_kernarg_size 80
  .amdhsa_user_sgpr_count 2
  .amdhsa_user_sgpr_kernarg_segment_ptr 1
  .amdhsa_system_sgpr_workgroup_id_x 1
  .amdhsa_float_denorm_mode_32 3
.end_amdhsa_kernel
```
